```python
import torch

def _softmax(x, axis=-1):
    return torch.softmax(x, dim=axis)
def _gelu(x):
    return torch.nn.functional.gelu(x, approximate="tanh")
def _silu(x):
    return torch.nn.functional.silu(x)
def _sigmoid(x):
    return torch.sigmoid(x)
def _layernorm(x, axis=-1, eps=1e-5):
    m = x.mean(dim=axis, keepdim=True)
    v = x.var(dim=axis, keepdim=True, unbiased=False)
    return (x - m) / torch.sqrt(v + eps)
def _scatter_add(tgt, idx, src, axis=0):
    return tgt.clone().index_add_(axis, idx, src)
def _segment_sum(src, seg, n):
    out = torch.zeros((n,) + src.shape[1:], dtype=src.dtype)
    return out.index_add_(0, seg, src)
def _pad(x, pw):
    flat = tuple(v for pair in reversed(pw) for v in pair)
    return torch.nn.functional.pad(x, flat)

kernel_name = 'recurrent_scan__compressed_kv_cla__dense_activation_silu__decode'

def setup_inputs():

    _w = (lambda a: (lambda t: t.to(torch.bfloat16) if t.is_floating_point() else t)(torch.as_tensor(a)))
    def _A_setup():
        B, H, Sq, Sk, D, M = 1, 32, 1, 32768, 128, 512
        Dc = 4 * D
        return {
            "x": _w((lambda *s: torch.randn(*s, dtype=torch.bfloat16) * 0.1)(B, Sq, M)),
            "c_kv": _w((lambda *s: torch.randn(*s, dtype=torch.bfloat16) * 3.2)(B, Sk, Dc)),
            "w_q": _w((lambda *s: torch.randn(*s, dtype=torch.bfloat16) * 0.8)(M, H, D) * (M ** -0.5)),
            "w_uk": _w((lambda *s: torch.randn(*s, dtype=torch.bfloat16) * 0.8)(Dc, H, D) * (Dc ** -0.5)),
            "w_uv": _w((lambda *s: torch.randn(*s, dtype=torch.bfloat16) * 3.2)(Dc, H, D) * (Dc ** -0.5)),
            "w_o": _w((lambda *s: torch.randn(*s, dtype=torch.bfloat16) * 3.2)(H, D, M) * ((H * D) ** -0.5)),
        }
    _A_in = _A_setup()

    def _B_setup():
        B, S, D, F = 1, 1, 512, 1376
        return {
            "x": _w((lambda *s: torch.randn(*s, dtype=torch.bfloat16) * 0.1)(B, S, D)),
            "w1": _w((lambda *s: torch.randn(*s, dtype=torch.bfloat16) * 3.2)(D, F) * (D ** -0.5)),
            "w2": _w((lambda *s: torch.randn(*s, dtype=torch.bfloat16) * 0.8)(F, D) * (F ** -0.5)),
        }
    _B_in = _B_setup()

    return {
        "A_x": _A_in["x"],
        "A_c_kv": _A_in["c_kv"],
        "A_w_q": _A_in["w_q"],
        "A_w_uk": _A_in["w_uk"],
        "A_w_uv": _A_in["w_uv"],
        "A_w_o": _A_in["w_o"],
        "B_x": _B_in["x"],
        "B_w1": _B_in["w1"],
        "B_w2": _B_in["w2"],
    }

def reference(A_x, A_c_kv, A_w_q, A_w_uk, A_w_uv, A_w_o, B_x, B_w1, B_w2):
    def _A_ref(x, c_kv, w_q, w_uk, w_uv, w_o):
        B, Sq, M = x.shape[0], x.shape[1], x.shape[2]
        Sk = c_kv.shape[1]
        H, D = w_q.shape[1], w_q.shape[2]
        q = torch.einsum("bqm,mhd->bhqd", x, w_q)
        k = torch.einsum("bkc,chd->bhkd", c_kv, w_uk)
        v = torch.einsum("bkc,chd->bhkd", c_kv, w_uv)
        scores = torch.einsum("bhqd,bhkd->bhqk", q, k) * (D ** -0.5)
        off = Sk - Sq
        qi = torch.arange(Sq)[:, None]
        kj = torch.arange(Sk)[None, :]
        cmask = kj <= (qi + off)
        scores = torch.where(cmask[None, None], scores, -1e9)
        p = _softmax(scores, axis=-1)
        ctx = torch.einsum("bhqk,bhkd->bhqd", p, v)
        return torch.einsum("bhqd,hdm->bqm", ctx, w_o)

    def _B_ref(x, w1, w2):
        h = torch.einsum("bsd,df->bsf", x, w1)
        h = _silu(h)
        out = torch.einsum("bsf,fd->bsd", h, w2)
        return out

    x = A_x
    xn = _layernorm(x, axis=-1)
    s = _A_ref(xn, A_c_kv, A_w_q, A_w_uk, A_w_uv, A_w_o)
    g = _silu(_B_ref(xn, B_w1, B_w2))
    return x + s * g
```

```asm
; @launch grid=(256,1,1) block=(512,1,1) lds=163840
.amdgcn_target "amdgcn-amd-amdhsa--gfx950"
.text
.globl recurrent_scan__compressed_kv_cla__dense_activation_silu__decode_kernel
.p2align 8
.type recurrent_scan__compressed_kv_cla__dense_activation_silu__decode_kernel,@function
recurrent_scan__compressed_kv_cla__dense_activation_silu__decode_kernel:
    s_load_dwordx16 s[16:31], s[0:1], 0
    s_load_dwordx8 s[32:39], s[0:1], 64
    s_memrealtime s[4:5]
    s_cmp_ge_u32 s2, 256
    s_cbranch_scc1 L_end
    s_getpc_b64 s[6:7]
L_pc:
    v_lshrrev_b32 v1, 6, v0
    s_nop 0
    v_readfirstlane_b32 s3, v1
    v_and_b32 v1, 63, v0

    s_cmp_ge_u32 s2, 128
    s_cbranch_scc1 L_W
    s_cmp_lg_u32 s3, 6
    s_cbranch_scc1 L_nopf
    v_lshlrev_b32 v2, 7, v1
    global_load_dword v255, v2, s[6:7]
    v_add_u32 v2, 0x2000, v2
    v_min_u32 v3, L_end-L_pc, v2
    global_load_dword v255, v3, s[6:7]
    v_add_u32 v2, 0x2000, v2
    v_min_u32 v3, L_end-L_pc, v2
    global_load_dword v255, v3, s[6:7]
L_nopf:
    s_lshl_b32 s8, s3, 3
    s_or_b32 s8, s8, s2
    s_sub_u32 s8, s8, 56
    v_mov_b32 v5, 0
    v_mov_b32 v6, 0
    s_waitcnt lgkmcnt(0)
    s_cmp_ge_u32 s2, 8
    s_cbranch_scc1 L_A
    s_cmp_ge_u32 s8, 8
    s_cbranch_scc1 L_A
    s_or_b32 s8, s4, 1
    v_mov_b32 v4, s8
    s_mov_b64 exec, 1
    global_atomic_cmpswap v6, v[4:5], s[36:37] sc1
    s_mov_b64 exec, -1
    s_branch L_A

L_W:
    s_and_b32 s8, s2, 7
    s_lshr_b32 s9, s2, 3
    s_sub_u32 s9, s9, 16
    s_lshr_b32 s10, s9, 2
    s_lshl_b32 s11, s8, 2
    s_add_u32 s10, s10, s11
    s_and_b32 s11, s9, 3
    s_lshl_b32 s13, s10, 8
    v_lshlrev_b32 v9, 4, v1
    v_lshrrev_b32 v6, 4, v1
    v_and_b32 v7, 15, v1
    v_lshlrev_b32 v8, 1, v6
    v_xor_b32 v8, v8, v7
    v_lshlrev_b32 v8, 4, v8
    v_lshl_add_u32 v2, v6, 13, v8
    v_xor_b32 v3, 0x80, v2
    s_lshl_b32 s14, s11, 3
    s_add_u32 s14, s14, s3
    s_lshl_b32 s15, s14, 17
    s_add_u32 s15, s15, s13
    s_lshl_b32 s14, s3, 12
    v_lshlrev_b32 v10, 2, v6
    v_xor_b32 v10, v10, v7
    v_lshlrev_b32 v10, 4, v10
    v_lshl_add_u32 v10, v6, 13, v10
    v_xor_b32 v11, 32, v10
    s_mov_b32 s42, 0x400000
    s_mov_b32 s43, 0x20000
    s_mov_b32 s50, 0x400000
    s_mov_b32 s51, 0x20000
    s_mov_b32 m0, s14
    s_waitcnt lgkmcnt(0)
    s_mov_b32 s40, s20
    s_mov_b32 s41, s21
    s_cmp_lg_u32 s3, 0
    s_cbranch_scc1 L_Wx
    global_load_dwordx4 v[68:71], v9, s[16:17]
L_Wx:

    buffer_load_dwordx4 v2, s[40:43], s15 offen nt lds
    s_add_u32 m0, s14, 1024
    s_add_u32 s60, s15, 32768
    buffer_load_dwordx4 v2, s[40:43], s60 offen nt lds
    s_add_u32 m0, s14, 2048
    s_add_u32 s60, s15, 65536
    buffer_load_dwordx4 v3, s[40:43], s60 offen nt lds
    s_add_u32 m0, s14, 3072
    s_add_u32 s60, s15, 98304
    buffer_load_dwordx4 v3, s[40:43], s60 offen nt lds
    s_mov_b32 s48, s22
    s_mov_b32 s49, s23
    s_barrier
    s_add_u32 m0, s14, 32768
    s_add_u32 s60, s15, 0
    buffer_load_dwordx4 v10, s[48:51], s60 offen nt lds
    s_add_u32 m0, s14, 33792
    s_add_u32 s60, s15, 32768
    buffer_load_dwordx4 v10, s[48:51], s60 offen nt lds
    s_add_u32 m0, s14, 34816
    s_add_u32 s60, s15, 65536
    buffer_load_dwordx4 v11, s[48:51], s60 offen nt lds
    s_add_u32 m0, s14, 35840
    s_add_u32 s60, s15, 98304
    buffer_load_dwordx4 v11, s[48:51], s60 offen nt lds
    s_mov_b32 s44, s38
    s_mov_b32 s45, s39
    s_mov_b32 s46, 0x520000
    s_mov_b32 s47, 0x20000
    s_mov_b32 s52, 0xffff0000
    s_mov_b32 s53, 0
    s_mov_b32 s54, 0
    s_mov_b32 s55, 0x0000ffff
    s_mov_b32 s56, 0
    s_mov_b32 s57, 0xffff0000

    v_mov_b32 v14, 0
    s_cmp_lg_u32 s3, 0
    s_cbranch_scc1 L_Wln
    s_waitcnt vmcnt(8)
    s_load_dword s4, s[36:37], 0

    v_lshlrev_b32 v72, 16, v68
    v_and_b32 v73, 0xffff0000, v68
    v_lshlrev_b32 v74, 16, v69
    v_and_b32 v75, 0xffff0000, v69
    v_lshlrev_b32 v76, 16, v70
    v_and_b32 v77, 0xffff0000, v70
    v_lshlrev_b32 v78, 16, v71
    v_and_b32 v79, 0xffff0000, v71
    v_readfirstlane_b32 s60, v72
    s_nop 1
    v_subrev_f32 v84, s60, v72
    v_subrev_f32 v85, s60, v73
    v_subrev_f32 v86, s60, v74
    v_subrev_f32 v87, s60, v75
    v_subrev_f32 v88, s60, v76
    v_subrev_f32 v89, s60, v77
    v_subrev_f32 v90, s60, v78
    v_subrev_f32 v91, s60, v79
    v_add_f32 v80, v84, v85
    v_mul_f32 v82, v84, v84
    v_add_f32 v81, v86, v87
    v_mul_f32 v83, v85, v85
    v_add_f32 v92, v88, v89
    v_fmac_f32 v82, v86, v86
    v_add_f32 v93, v90, v91
    v_fmac_f32 v83, v87, v87
    v_add_f32 v80, v80, v81
    v_fmac_f32 v82, v88, v88
    v_add_f32 v92, v92, v93
    v_fmac_f32 v83, v89, v89
    v_add_f32 v80, v80, v92
    v_fmac_f32 v82, v90, v90
    v_fmac_f32 v83, v91, v91
    v_add_f32 v82, v82, v83

    v_add_f32_dpp v80, v80, v80 quad_perm:[1,0,3,2] row_mask:0xf bank_mask:0xf
    s_nop 0
    v_add_f32_dpp v82, v82, v82 quad_perm:[1,0,3,2] row_mask:0xf bank_mask:0xf
    v_add_f32_dpp v80, v80, v80 quad_perm:[2,3,0,1] row_mask:0xf bank_mask:0xf
    s_nop 0
    v_add_f32_dpp v82, v82, v82 quad_perm:[2,3,0,1] row_mask:0xf bank_mask:0xf
    v_add_f32_dpp v80, v80, v80 row_half_mirror row_mask:0xf bank_mask:0xf
    s_nop 0
    v_add_f32_dpp v82, v82, v82 row_half_mirror row_mask:0xf bank_mask:0xf
    v_add_f32_dpp v80, v80, v80 row_mirror row_mask:0xf bank_mask:0xf
    s_nop 0
    v_add_f32_dpp v82, v82, v82 row_mirror row_mask:0xf bank_mask:0xf
    v_mov_b32 v81, v80
    v_mov_b32 v83, v82
    s_nop 0
    v_permlane16_swap_b32 v80, v81
    v_permlane16_swap_b32 v82, v83
    v_add_f32 v80, v80, v81
    v_add_f32 v82, v82, v83
    v_mov_b32 v81, v80
    v_mov_b32 v83, v82
    s_nop 0
    v_permlane32_swap_b32 v80, v81
    v_permlane32_swap_b32 v82, v83
    v_add_f32 v80, v80, v81
    v_add_f32 v82, v82, v83
    v_mul_f32 v80, 0x3b000000, v80
    v_mul_f32 v82, 0x3b000000, v82
    v_fma_f32 v82, -v80, v80, v82
    v_add_f32 v80, s60, v80
    v_max_f32 v82, 0, v82
    v_cvt_pk_bf16_f32 v80, v80, v82
    v_and_b32 v82, 0xffff0000, v80
    v_lshlrev_b32 v80, 16, v80
    v_add_f32 v82, 0x3727c5ac, v82
    v_sub_f32 v72, v72, v80
    v_sub_f32 v73, v73, v80
    v_sub_f32 v74, v74, v80
    v_sub_f32 v75, v75, v80
    v_cvt_pk_bf16_f32 v82, v82, v82
    v_lshlrev_b32 v82, 16, v82
    v_sqrt_f32 v82, v82
    v_sub_f32 v76, v76, v80
    v_sub_f32 v77, v77, v80
    v_sub_f32 v78, v78, v80
    v_sub_f32 v79, v79, v80
    v_cvt_pk_bf16_f32 v82, v82, v82
    v_lshlrev_b32 v82, 16, v82
    v_rcp_f32 v82, v82
    v_cvt_pk_bf16_f32 v68, v72, v73
    v_cvt_pk_bf16_f32 v69, v74, v75
    v_cvt_pk_bf16_f32 v70, v76, v77
    v_cvt_pk_bf16_f32 v71, v78, v79
    v_lshlrev_b32 v72, 16, v68
    v_and_b32 v73, 0xffff0000, v68
    v_lshlrev_b32 v74, 16, v69
    v_and_b32 v75, 0xffff0000, v69
    v_lshlrev_b32 v76, 16, v70
    v_and_b32 v77, 0xffff0000, v70
    v_lshlrev_b32 v78, 16, v71
    v_and_b32 v79, 0xffff0000, v71
    v_mul_f32 v72, v72, v82
    v_mul_f32 v73, v73, v82
    v_mul_f32 v74, v74, v82
    v_mul_f32 v75, v75, v82
    v_mul_f32 v76, v76, v82
    v_mul_f32 v77, v77, v82
    v_mul_f32 v78, v78, v82
    v_mul_f32 v79, v79, v82
    v_cvt_pk_bf16_f32 v68, v72, v73
    v_cvt_pk_bf16_f32 v69, v74, v75
    v_cvt_pk_bf16_f32 v70, v76, v77
    v_cvt_pk_bf16_f32 v71, v78, v79
    v_add_u32 v72, 0x20000, v9
    ds_write_b128 v72, v[68:71]
    s_waitcnt lgkmcnt(0)
    s_mov_b32 s60, 0
    s_branch L_Wn_c
L_Wn:
    global_load_dword v15, v14, s[36:37] sc1
    s_add_u32 s60, s60, 1
    s_waitcnt vmcnt(0)
    v_readfirstlane_b32 s4, v15
    s_cmp_gt_u32 s60, 60000
    s_cbranch_scc1 L_Wn_x
L_Wn_c:
    s_cmp_eq_u32 s4, 0
    s_cbranch_scc1 L_Wn
L_Wn_x:
    v_mov_b32 v72, 0x20600
    v_mov_b32 v15, s4
    ds_write_b32 v72, v15
    s_waitcnt lgkmcnt(0)
L_Wln:

    s_lshl_b32 s12, s9, 3
    s_add_u32 s12, s12, s8
    s_cmp_lt_u32 s9, 11
    s_cselect_b32 s12, s12, 1000
    v_mov_b32 v14, 0
    v_lshrrev_b32 v12, 2, v7
    v_and_b32 v13, 1, v6
    v_lshl_add_u32 v13, v13, 2, v12
    v_lshlrev_b32 v13, 1, v13
    v_bfe_u32 v16, v1, 1, 1
    s_lshl_b32 s60, s3, 1
    v_add_u32 v16, s60, v16
    v_xor_b32 v16, v16, v13
    v_lshlrev_b32 v16, 4, v16
    v_lshl_add_u32 v13, v6, 3, v12
    v_lshl_add_u32 v16, v13, 8, v16
    v_and_b32 v13, 1, v1
    v_lshl_add_u32 v4, v13, 3, v16
    v_lshlrev_b32 v5, 4, v6
    v_add_u32 v5, 0x20000, v5
    v_and_b32 v13, 3, v7
    v_and_b32 v16, 2, v12
    v_xor_b32 v16, v16, v6
    v_lshl_add_u32 v16, v13, 2, v16
    v_lshlrev_b32 v16, 4, v16
    v_lshl_add_u32 v16, v7, 8, v16
    s_add_u32 s60, s14, 0x8000
    v_add_u32 v64, s60, v16
    v_xor_b32 v65, 64, v64
    v_xor_b32 v66, 0x80, v64
    v_xor_b32 v67, 0xc0, v64

    s_waitcnt vmcnt(4)
    s_barrier
    s_lshl_b32 s60, s11, 8
    v_add_u32 v13, s60, v5
    ds_read_b128 v[16:19], v13 offset:0
    ds_read_b64_tr_b16 v[36:37], v4 offset:0
    ds_read_b64_tr_b16 v[38:39], v4 offset:1024
    ds_read_b128 v[20:23], v13 offset:64
    ds_read_b64_tr_b16 v[40:41], v4 offset:8192
    ds_read_b64_tr_b16 v[42:43], v4 offset:9216
    ds_read_b128 v[24:27], v13 offset:128
    ds_read_b64_tr_b16 v[44:45], v4 offset:16384
    ds_read_b64_tr_b16 v[46:47], v4 offset:17408
    ds_read_b128 v[28:31], v13 offset:192
    ds_read_b64_tr_b16 v[48:49], v4 offset:24576
    ds_read_b64_tr_b16 v[50:51], v4 offset:25600
    v_mov_b32 v12, 0x20600
    ds_read_b32 v53, v12
    s_lshl_b32 s60, s10, 12
    s_lshl_b32 s61, s3, 7
    s_add_u32 s60, s60, s61
    s_add_u32 s60, s60, 0xe0000
    s_lshl_b32 s61, s11, 10
    s_add_u32 s61, s61, s60
    v_lshlrev_b32 v12, 3, v7
    v_lshl_add_u32 v13, v6, 10, v12
    v_cmp_ne_u32 s[64:65], s11, v6

    s_waitcnt lgkmcnt(10)
    v_mfma_f32_16x16x32_bf16 v[32:35], v[16:19], v[36:39], 0
    s_waitcnt lgkmcnt(7)
    v_mfma_f32_16x16x32_bf16 v[32:35], v[20:23], v[40:43], v[32:35]
    s_waitcnt lgkmcnt(4)
    v_mfma_f32_16x16x32_bf16 v[32:35], v[24:27], v[44:47], v[32:35]
    s_waitcnt lgkmcnt(1)
    v_mfma_f32_16x16x32_bf16 v[32:35], v[28:31], v[48:51], v[32:35]
    s_waitcnt lgkmcnt(0)
    s_lshl_b32 s62, s3, 5
    s_add_u32 s62, s62, 0x20400
    v_lshl_add_u32 v15, v7, 1, s62
    v_mov_b32 v55, v53
    s_nop 2
    v_mov_b32 v52, v32
    v_mov_b32 v54, v32
    s_mov_b64 exec, 0xffff
    buffer_store_dwordx2 v[52:53], v12, s[44:47], s61 offen sc1

    s_mov_b64 exec, -1
    s_lshl_b32 s68, s10, 2
    s_add_u32 s68, s68, s11
    s_lshl_b32 s69, s68, 15
    s_lshl_b32 s61, s3, 12
    s_add_u32 s69, s69, s61
    s_lshr_b32 s61, s10, 4
    s_lshl_b32 s61, s61, 12
    s_add_u32 s69, s69, s61
    s_add_u32 s69, s69, 0x100000
    s_lshl_b32 s58, s68, 11
    s_lshl_b32 s61, s3, 8
    s_add_u32 s58, s58, s61
    s_add_u32 s58, s58, 0x20000
    s_lshl_b32 s66, s12, 11
    s_add_u32 s66, s66, s61
    s_add_u32 s66, s66, 0x60000
    s_cmp_lt_u32 s12, 86
    s_cselect_b32 s66, s66, s58
    s_lshl_b32 s67, s3, 6
    s_add_u32 s67, s67, s11
    s_lshl_b32 s67, s67, 9
    s_lshl_b32 s61, s10, 4
    s_add_u32 s67, s67, s61
    s_add_u32 s67, s67, 0xa0000
    v_lshlrev_b32 v11, 2, v1
    v_mov_b32 v56, -1

    buffer_store_dword v56, v11, s[44:47], s58 offen sc1
    buffer_store_dword v56, v11, s[44:47], s66 offen sc1
    s_waitcnt vmcnt(0)
    s_mov_b32 s62, 0
L_Wq:
    s_mov_b64 exec, s[64:65]
    buffer_load_dwordx2 v[54:55], v13, s[44:47], s60 offen sc1
    s_add_u32 s62, s62, 1
    s_waitcnt vmcnt(0)
    v_cmp_ne_u32 s[64:65], v55, v53
    s_cmp_gt_u32 s62, 60000
    s_cbranch_scc1 L_Wq_x
    s_cmp_lg_u64 s[64:65], 0
    s_cbranch_scc1 L_Wq
L_Wq_x:

    s_or_b32 s5, s3, s11
    s_cmp_lg_u32 s5, 0
    s_cbranch_scc1 L_Wef
    s_lshl_b32 s5, s10, 7
    s_add_u32 s5, s5, 0x10000
    s_mov_b64 exec, 0xffff
    v_mov_b32 v52, v53
    buffer_store_dwordx2 v[52:53], v12, s[44:47], s5 offen sc1
L_Wef:

    s_mov_b64 exec, -1
    ds_read_b128 v[16:19], v64
    ds_read_b128 v[20:23], v65
    ds_read_b128 v[24:27], v66
    ds_read_b128 v[28:31], v67
    v_mov_b32 v55, v54
    s_nop 1
    v_permlane16_swap_b32 v54, v55
    v_add_f32 v54, v54, v55
    v_mov_b32 v55, v54
    s_nop 1
    v_permlane32_swap_b32 v54, v55
    v_add_f32 v54, v54, v55
    v_cvt_pk_bf16_f32 v54, v54, v54
    ds_write_b16 v15, v54

    s_waitcnt lgkmcnt(0)
    s_barrier
    ds_read_b128 v[36:39], v5 offset:1024
    ds_read_b128 v[40:43], v5 offset:1088
    ds_read_b128 v[44:47], v5 offset:1152
    ds_read_b128 v[48:51], v5 offset:1216
    s_lshl_b32 s14, s3, 5
    s_add_u32 s14, s14, 0x20700
    v_lshl_add_u32 v13, v6, 3, s14
    v_lshlrev_b32 v12, 4, v7
    v_add_u32 v15, 0x20700, v12
    s_lshl_b32 s14, s68, 8
    s_lshl_b32 s15, s68, 5
    s_add_u32 s15, s15, 0x8000
    v_add_u32 v56, s14, v12
    v_add_u32 v57, s15, v12
    v_cndmask_b32 v56, v56, v57, s[52:53]

    s_waitcnt lgkmcnt(3)
    v_mfma_f32_16x16x32_bf16 v[32:35], v[16:19], v[36:39], 0
    s_waitcnt lgkmcnt(2)
    v_mfma_f32_16x16x32_bf16 v[32:35], v[20:23], v[40:43], v[32:35]
    s_waitcnt lgkmcnt(1)
    v_mfma_f32_16x16x32_bf16 v[32:35], v[24:27], v[44:47], v[32:35]
    s_waitcnt lgkmcnt(0)
    v_mfma_f32_16x16x32_bf16 v[32:35], v[28:31], v[48:51], v[32:35]
    s_nop 7
    v_mul_f32 v32, 0x3e0293ee, v32
    v_mul_f32 v33, 0x3e0293ee, v33
    v_mul_f32 v34, 0x3e0293ee, v34
    v_mul_f32 v35, 0x3e0293ee, v35
    v_cvt_pk_bf16_f32 v32, v32, v33
    v_cvt_pk_bf16_f32 v33, v34, v35
    ds_write_b64 v13, v[32:33]
    s_waitcnt lgkmcnt(0)
    s_barrier
    s_cmp_lg_u32 s3, 0
    s_cbranch_scc1 L_Wpub
    ds_read_b128 v[32:35], v15
    s_waitcnt lgkmcnt(0)
    v_add3_u32 v36, v32, v33, v34
    v_add_u32 v36, v36, v35

    s_nop 1
    v_add_u32_dpp v36, v36, v36 quad_perm:[1,0,3,2] row_mask:0xf bank_mask:0xf
    s_nop 1
    v_add_u32_dpp v36, v36, v36 quad_perm:[2,3,0,1] row_mask:0xf bank_mask:0xf
    s_nop 1
    v_add_u32_dpp v36, v36, v36 row_half_mirror row_mask:0xf bank_mask:0xf
    s_nop 1
    v_add_u32_dpp v36, v36, v36 row_mirror row_mask:0xf bank_mask:0xf
    v_sub_u32 v36, v53, v36
    v_cndmask_b32 v32, v32, v36, s[52:53]
    v_cndmask_b32 v33, v33, v53, s[52:53]
    s_mov_b64 exec, 0x3ffff
    buffer_store_dwordx4 v[32:35], v56, s[44:47], 0 offen sc1
    s_mov_b64 exec, -1
L_Wpub:
    s_barrier

    s_mov_b32 s40, s24
    s_mov_b32 s41, s25
    s_mov_b32 s42, 0x400000
    s_mov_b32 s43, 0x20000
    s_mov_b32 s48, s26
    s_mov_b32 s49, s27
    s_mov_b32 s50, 0x400000
    s_mov_b32 s51, 0x20000
    s_mov_b32 s16, s30
    s_mov_b32 s17, s31
    s_mov_b32 s18, 1409024
    s_mov_b32 s19, 0x20000
    s_mov_b32 s20, s32
    s_mov_b32 s21, s33
    s_mov_b32 s22, 1409024
    s_mov_b32 s23, 0x20000
    v_readfirstlane_b32 s4, v53
    v_lshrrev_b32 v12, 3, v1
    v_and_b32 v13, 7, v1
    v_lshlrev_b32 v70, 4, v13
    v_lshl_add_u32 v70, v12, 10, v70
    v_bfe_u32 v15, v1, 4, 1
    v_lshlrev_b32 v15, 5, v15
    v_xor_b32 v68, v70, v15
    v_xor_b32 v69, 64, v68
    v_mul_u32_u24 v10, 2752, v6
    s_and_b32 s60, s3, 1
    s_lshl_b32 s60, s60, 7
    v_xor_b32 v13, s60, v8
    v_add_u32 v10, v10, v13
    s_lshl_b32 s24, s8, 3
    s_add_u32 s24, s24, s3
    s_mul_i32 s24, s24, 22016
    s_lshl_b32 s60, s9, 8
    s_add_u32 s24, s24, s60
    s_lshl_b32 s25, s12, 14
    s_lshl_b32 s60, s3, 7
    s_add_u32 s25, s25, s60
    s_cmp_lt_u32 s12, 88
    s_cselect_b32 s24, s24, 0x1000000
    s_lshl_b32 s26, s3, 11
    v_lshl_add_u32 v2, v6, 17, v8
    v_xor_b32 v3, 0x80, v2
    s_lshl_b32 s27, s11, 5
    s_add_u32 s27, s27, s3
    s_lshl_b32 s27, s27, 14
    s_add_u32 s27, s27, s13
    s_lshl_b32 s28, s3, 12
    s_lshl_b32 s14, s10, 17
    s_lshl_b32 s15, s3, 7
    s_add_u32 s14, s14, s15
    s_lshl_b32 s15, s3, 13
    s_add_u32 s15, s15, 0x10000
    v_lshrrev_b32 v71, 2, v7
    v_lshl_add_u32 v71, v6, 3, v71
    v_lshlrev_b32 v71, 7, v71
    v_and_b32 v13, 3, v1
    v_lshl_add_u32 v71, v13, 3, v71
    v_bfe_u32 v13, v1, 3, 2
    v_lshl_add_u32 v71, v13, 5, v71
    v_add_u32 v71, s15, v71

    s_add_u32 m0, s15, 0
    s_add_u32 s60, s14, 0
    buffer_load_dwordx4 v68, s[48:51], s60 offen nt lds
    s_add_u32 m0, s15, 1024
    s_add_u32 s60, s14, 8192
    buffer_load_dwordx4 v69, s[48:51], s60 offen nt lds
    s_add_u32 m0, s15, 2048
    s_add_u32 s60, s14, 16384
    buffer_load_dwordx4 v68, s[48:51], s60 offen nt lds
    s_waitcnt vmcnt(2)
    s_add_u32 m0, s15, 3072
    s_add_u32 s60, s14, 24576
    buffer_load_dwordx4 v69, s[48:51], s60 offen nt lds
    s_waitcnt vmcnt(2)
    s_add_u32 m0, s26, 0x8000
    s_add_u32 s60, s24, 0
    buffer_load_dwordx4 v10, s[16:19], s60 offen nt lds
    s_waitcnt vmcnt(2)
    s_add_u32 m0, s15, 4096
    s_add_u32 s60, s14, 32768
    buffer_load_dwordx4 v68, s[48:51], s60 offen nt lds
    s_waitcnt vmcnt(2)
    s_add_u32 m0, s26, 0x8400
    s_add_u32 s60, s24, 11008
    buffer_load_dwordx4 v10, s[16:19], s60 offen nt lds
    s_waitcnt vmcnt(2)
    s_add_u32 m0, s15, 5120
    s_add_u32 s60, s14, 40960
    buffer_load_dwordx4 v69, s[48:51], s60 offen nt lds
    s_waitcnt vmcnt(2)
    s_add_u32 m0, s26, 0xc000
    s_add_u32 s60, s25, 0
    buffer_load_dwordx4 v70, s[20:23], s60 offen nt lds
    s_waitcnt vmcnt(2)
    s_add_u32 m0, s15, 6144
    s_add_u32 s60, s14, 49152
    buffer_load_dwordx4 v68, s[48:51], s60 offen nt lds
    s_waitcnt vmcnt(2)
    s_add_u32 m0, s26, 0xc400
    s_add_u32 s60, s25, 8192
    buffer_load_dwordx4 v70, s[20:23], s60 offen nt lds
    s_waitcnt vmcnt(2)
    s_add_u32 m0, s15, 7168
    s_add_u32 s60, s14, 57344
    buffer_load_dwordx4 v69, s[48:51], s60 offen nt lds
    v_xor_b32 v13, 0x0, v71
    ds_read_b64_tr_b16 v[72:73], v13 offset:0
    ds_read_b64_tr_b16 v[74:75], v13 offset:512
    v_xor_b32 v13, 0x20, v71
    ds_read_b64_tr_b16 v[88:89], v13 offset:0
    ds_read_b64_tr_b16 v[90:91], v13 offset:512
    v_xor_b32 v13, 0x40, v71
    ds_read_b64_tr_b16 v[104:105], v13 offset:0
    ds_read_b64_tr_b16 v[106:107], v13 offset:512
    v_xor_b32 v13, 0x60, v71
    ds_read_b64_tr_b16 v[120:121], v13 offset:0
    ds_read_b64_tr_b16 v[122:123], v13 offset:512
    s_waitcnt lgkmcnt(0)
    s_waitcnt vmcnt(2)
    s_add_u32 m0, s15, 0
    s_add_u32 s60, s14, 65536
    buffer_load_dwordx4 v68, s[48:51], s60 offen nt lds
    s_waitcnt vmcnt(2)
    s_add_u32 m0, s15, 1024
    s_add_u32 s60, s14, 73728
    buffer_load_dwordx4 v69, s[48:51], s60 offen nt lds
    s_add_u32 m0, s28, 0
    s_add_u32 s60, s27, 0
    buffer_load_dwordx4 v2, s[40:43], s60 offen nt lds
    s_barrier
    s_cmp_ge_u32 s12, 88
    s_cbranch_scc1 L_Wnf2
    s_lshl_b32 s60, s8, 7
    v_add_u32 v13, s60, v5
    v_add_u32 v15, 0x8000, v4

    ds_read_b128 v[52:55], v13 offset:0
    ds_read_b64_tr_b16 v[36:37], v15 offset:0
    ds_read_b64_tr_b16 v[38:39], v15 offset:1024
    ds_read_b128 v[56:59], v13 offset:64
    ds_read_b64_tr_b16 v[40:41], v15 offset:8192
    ds_read_b64_tr_b16 v[42:43], v15 offset:9216
    v_lshrrev_b32 v12, 2, v1
    v_and_b32 v13, 3, v1
    v_lshlrev_b32 v13, 3, v13
    v_lshl_add_u32 v12, v12, 7, v13
    s_lshl_b32 s60, s3, 11
    s_add_u32 s60, s60, 0xc000
    v_add_u32 v12, s60, v12
    s_waitcnt lgkmcnt(0)
    v_mfma_f32_16x16x32_bf16 v[32:35], v[52:55], v[36:39], 0
    v_mfma_f32_16x16x32_bf16 v[32:35], v[56:59], v[40:43], v[32:35]

    ds_read_b64_tr_b16 v[44:45], v12 offset:0
    ds_read_b64_tr_b16 v[46:47], v12 offset:32
    ds_read_b64_tr_b16 v[48:49], v12 offset:64
    ds_read_b64_tr_b16 v[50:51], v12 offset:96
    s_lshl_b32 s60, s12, 10
    s_lshl_b32 s61, s3, 7
    s_add_u32 s60, s60, s61
    s_add_u32 s60, s60, 0x504000
    v_lshlrev_b32 v12, 3, v7
    v_mov_b32 v33, s4
    s_mov_b64 exec, 0xffff
    buffer_store_dwordx2 v[32:33], v12, s[44:47], s60 offen sc1
    s_mov_b64 exec, -1
L_Wnf2:
    s_waitcnt lgkmcnt(0)

    s_waitcnt vmcnt(3)
    s_add_u32 m0, s15, 2048
    s_add_u32 s60, s14, 81920
    buffer_load_dwordx4 v68, s[48:51], s60 offen nt lds
    s_waitcnt vmcnt(3)
    s_add_u32 m0, s15, 3072
    s_add_u32 s60, s14, 90112
    buffer_load_dwordx4 v69, s[48:51], s60 offen nt lds
    s_waitcnt vmcnt(3)
    s_add_u32 m0, s28, 1024
    s_add_u32 s60, s27, 2097152
    buffer_load_dwordx4 v2, s[40:43], s60 offen nt lds
    v_xor_b32 v13, 0x0, v71
    ds_read_b64_tr_b16 v[76:77], v13 offset:4096
    ds_read_b64_tr_b16 v[78:79], v13 offset:4608
    v_xor_b32 v13, 0x20, v71
    ds_read_b64_tr_b16 v[92:93], v13 offset:4096
    ds_read_b64_tr_b16 v[94:95], v13 offset:4608
    v_xor_b32 v13, 0x40, v71
    ds_read_b64_tr_b16 v[108:109], v13 offset:4096
    ds_read_b64_tr_b16 v[110:111], v13 offset:4608
    v_xor_b32 v13, 0x60, v71
    ds_read_b64_tr_b16 v[124:125], v13 offset:4096
    ds_read_b64_tr_b16 v[126:127], v13 offset:4608
    s_waitcnt lgkmcnt(0)
    s_waitcnt vmcnt(3)
    s_add_u32 m0, s15, 4096
    s_add_u32 s60, s14, 98304
    buffer_load_dwordx4 v68, s[48:51], s60 offen nt lds
    s_waitcnt vmcnt(3)
    s_add_u32 m0, s15, 5120
    s_add_u32 s60, s14, 106496
    buffer_load_dwordx4 v69, s[48:51], s60 offen nt lds
    s_waitcnt vmcnt(3)
    s_add_u32 m0, s28, 2048
    s_add_u32 s60, s27, 8192
    buffer_load_dwordx4 v3, s[40:43], s60 offen nt lds
    s_waitcnt vmcnt(3)
    s_add_u32 m0, s15, 6144
    s_add_u32 s60, s14, 114688
    buffer_load_dwordx4 v68, s[48:51], s60 offen nt lds
    s_waitcnt vmcnt(3)
    s_add_u32 m0, s15, 7168
    s_add_u32 s60, s14, 122880
    buffer_load_dwordx4 v69, s[48:51], s60 offen nt lds
    s_waitcnt vmcnt(3)
    s_add_u32 m0, s28, 3072
    s_add_u32 s60, s27, 2105344
    buffer_load_dwordx4 v3, s[40:43], s60 offen nt lds
    v_xor_b32 v13, 0x0, v71
    ds_read_b64_tr_b16 v[80:81], v13 offset:0
    ds_read_b64_tr_b16 v[82:83], v13 offset:512
    v_xor_b32 v13, 0x20, v71
    ds_read_b64_tr_b16 v[96:97], v13 offset:0
    ds_read_b64_tr_b16 v[98:99], v13 offset:512
    v_xor_b32 v13, 0x40, v71
    ds_read_b64_tr_b16 v[112:113], v13 offset:0
    ds_read_b64_tr_b16 v[114:115], v13 offset:512
    v_xor_b32 v13, 0x60, v71
    ds_read_b64_tr_b16 v[128:129], v13 offset:0
    ds_read_b64_tr_b16 v[130:131], v13 offset:512
    s_waitcnt lgkmcnt(0)
    s_cmp_ge_u32 s12, 86
    s_cbranch_scc1 L_Wnf3
    s_lshl_b32 s60, s9, 13
    s_lshl_b32 s61, s8, 7
    s_add_u32 s60, s60, s61
    s_add_u32 s60, s60, 0x504000
    v_and_b32 v12, 7, v1
    v_lshlrev_b32 v12, 10, v12
    v_lshl_add_u32 v12, v6, 5, v12
    s_mov_b32 s61, 0
L_Wh:
    buffer_load_dwordx4 v[52:55], v12, s[44:47], s60 offen sc1
    buffer_load_dwordx4 v[56:59], v12, s[44:47], s60 offen offset:16 sc1
    s_add_u32 s61, s61, 1
    s_waitcnt vmcnt(0)
    v_xor_b32 v13, v53, v55
    v_xor_b32 v14, v57, v59
    v_xor_b32 v15, s4, v53
    v_or3_b32 v13, v13, v14, v15
    v_xor_b32 v14, v53, v57
    v_or_b32 v13, v13, v14
    v_cmp_ne_u32 vcc, 0, v13
    s_cmp_gt_u32 s61, 60000
    s_cbranch_scc1 L_Wh_x
    s_cbranch_vccnz L_Wh
L_Wh_x:

    v_add_f32_dpp v52, v52, v52 quad_perm:[1,0,3,2] row_mask:0xf bank_mask:0xf
    v_add_f32_dpp v54, v54, v54 quad_perm:[1,0,3,2] row_mask:0xf bank_mask:0xf
    v_add_f32_dpp v56, v56, v56 quad_perm:[1,0,3,2] row_mask:0xf bank_mask:0xf
    v_add_f32_dpp v58, v58, v58 quad_perm:[1,0,3,2] row_mask:0xf bank_mask:0xf
    v_add_f32_dpp v52, v52, v52 quad_perm:[2,3,0,1] row_mask:0xf bank_mask:0xf
    v_add_f32_dpp v54, v54, v54 quad_perm:[2,3,0,1] row_mask:0xf bank_mask:0xf
    v_add_f32_dpp v56, v56, v56 quad_perm:[2,3,0,1] row_mask:0xf bank_mask:0xf
    v_add_f32_dpp v58, v58, v58 quad_perm:[2,3,0,1] row_mask:0xf bank_mask:0xf
    v_add_f32_dpp v52, v52, v52 row_half_mirror row_mask:0xf bank_mask:0xf
    v_add_f32_dpp v54, v54, v54 row_half_mirror row_mask:0xf bank_mask:0xf
    v_add_f32_dpp v56, v56, v56 row_half_mirror row_mask:0xf bank_mask:0xf
    v_add_f32_dpp v58, v58, v58 row_half_mirror row_mask:0xf bank_mask:0xf
    v_cvt_pk_bf16_f32 v52, v52, v52
    v_lshlrev_b32 v52, 16, v52
    v_mul_f32 v53, 0xbfb8aa3b, v52
    v_exp_f32 v53, v53
    s_nop 0
    v_add_f32 v53, 1.0, v53
    v_rcp_f32 v53, v53
    s_nop 0
    v_mul_f32 v52, v52, v53
    v_cvt_pk_bf16_f32 v54, v54, v54
    v_lshlrev_b32 v54, 16, v54
    v_mul_f32 v53, 0xbfb8aa3b, v54
    v_exp_f32 v53, v53
    s_nop 0
    v_add_f32 v53, 1.0, v53
    v_rcp_f32 v53, v53
    s_nop 0
    v_mul_f32 v54, v54, v53
    v_cvt_pk_bf16_f32 v56, v56, v56
    v_lshlrev_b32 v56, 16, v56
    v_mul_f32 v53, 0xbfb8aa3b, v56
    v_exp_f32 v53, v53
    s_nop 0
    v_add_f32 v53, 1.0, v53
    v_rcp_f32 v53, v53
    s_nop 0
    v_mul_f32 v56, v56, v53
    v_cvt_pk_bf16_f32 v58, v58, v58
    v_lshlrev_b32 v58, 16, v58
    v_mul_f32 v53, 0xbfb8aa3b, v58
    v_exp_f32 v53, v53
    s_nop 0
    v_add_f32 v53, 1.0, v53
    v_rcp_f32 v53, v53
    s_nop 0
    v_mul_f32 v58, v58, v53
    v_cvt_pk_bf16_f32 v32, v52, v54
    v_cvt_pk_bf16_f32 v33, v56, v58
    s_nop 1
    v_mfma_f32_16x16x16_bf16 v[52:55], v[32:33], v[44:45], 0
    v_mfma_f32_16x16x16_bf16 v[56:59], v[32:33], v[46:47], 0
    v_mfma_f32_16x16x16_bf16 v[60:63], v[32:33], v[48:49], 0
    v_mfma_f32_16x16x16_bf16 v[64:67], v[32:33], v[50:51], 0
    s_nop 5
    v_cndmask_b32 v52, v52, v56, s[52:53]
    v_cndmask_b32 v52, v52, v60, s[54:55]
    v_cndmask_b32 v52, v52, v64, s[56:57]
    buffer_store_dword v52, v11, s[44:47], s66 offen sc1
L_Wnf3:

    s_waitcnt vmcnt(0)
    v_xor_b32 v13, 0x0, v71
    ds_read_b64_tr_b16 v[84:85], v13 offset:4096
    ds_read_b64_tr_b16 v[86:87], v13 offset:4608
    v_xor_b32 v13, 0x20, v71
    ds_read_b64_tr_b16 v[100:101], v13 offset:4096
    ds_read_b64_tr_b16 v[102:103], v13 offset:4608
    v_xor_b32 v13, 0x40, v71
    ds_read_b64_tr_b16 v[116:117], v13 offset:4096
    ds_read_b64_tr_b16 v[118:119], v13 offset:4608
    v_xor_b32 v13, 0x60, v71
    ds_read_b64_tr_b16 v[132:133], v13 offset:4096
    ds_read_b64_tr_b16 v[134:135], v13 offset:4608
    s_waitcnt lgkmcnt(0)
    v_cmp_eq_u32 vcc, 0, v7
    v_mov_b32 v56, 0
    v_mov_b32 v64, 0xffff
    v_cndmask_b32 v56, v56, v64, vcc
    v_cmp_eq_u32 vcc, 1, v7
    v_mov_b32 v64, 0xffff0000
    s_nop 0
    v_cndmask_b32 v56, v56, v64, vcc
    v_and_b32 v136, 0x3f803f80, v56
    v_and_b32 v140, 0x3f803f80, v56
    v_and_b32 v144, 0x3f803f80, v56
    v_and_b32 v148, 0x3f803f80, v56
    v_cmp_eq_u32 vcc, 2, v7
    v_mov_b32 v57, 0
    v_mov_b32 v64, 0xffff
    v_cndmask_b32 v57, v57, v64, vcc
    v_cmp_eq_u32 vcc, 3, v7
    v_mov_b32 v64, 0xffff0000
    s_nop 0
    v_cndmask_b32 v57, v57, v64, vcc
    v_and_b32 v137, 0x3f803f80, v57
    v_and_b32 v141, 0x3f803f80, v57
    v_and_b32 v145, 0x3f803f80, v57
    v_and_b32 v149, 0x3f803f80, v57
    v_cmp_eq_u32 vcc, 4, v7
    v_mov_b32 v58, 0
    v_mov_b32 v64, 0xffff
    v_cndmask_b32 v58, v58, v64, vcc
    v_cmp_eq_u32 vcc, 5, v7
    v_mov_b32 v64, 0xffff0000
    s_nop 0
    v_cndmask_b32 v58, v58, v64, vcc
    v_and_b32 v138, 0x3f803f80, v58
    v_and_b32 v142, 0x3f803f80, v58
    v_and_b32 v146, 0x3f803f80, v58
    v_and_b32 v150, 0x3f803f80, v58
    v_cmp_eq_u32 vcc, 6, v7
    v_mov_b32 v59, 0
    v_mov_b32 v64, 0xffff
    v_cndmask_b32 v59, v59, v64, vcc
    v_cmp_eq_u32 vcc, 7, v7
    v_mov_b32 v64, 0xffff0000
    s_nop 0
    v_cndmask_b32 v59, v59, v64, vcc
    v_and_b32 v139, 0x3f803f80, v59
    v_and_b32 v143, 0x3f803f80, v59
    v_and_b32 v147, 0x3f803f80, v59
    v_and_b32 v151, 0x3f803f80, v59
    v_lshrrev_b32 v64, 1, v6
    v_mul_u32_u24 v64, 0x900, v64
    v_lshl_add_u32 v64, v7, 4, v64
    v_and_b32 v65, 1, v6
    v_lshl_add_u32 v64, v65, 3, v64
    s_mul_i32 s60, s3, 288
    s_add_u32 s60, s60, 0x20800
    v_add_u32 v64, s60, v64
    v_and_b32 v65, 7, v1
    v_mul_u32_u24 v65, 288, v65
    v_add_u32 v65, v65, v5
    s_lshl_b32 s60, s3, 5
    s_add_u32 s60, s60, 0x20500
    v_lshl_add_u32 v66, v7, 1, s60

    s_waitcnt vmcnt(0)
    s_barrier
    ds_read_b64_tr_b16 v[16:17], v4 offset:0
    ds_read_b64_tr_b16 v[18:19], v4 offset:1024
    ds_read_b64_tr_b16 v[20:21], v4 offset:8192
    ds_read_b64_tr_b16 v[22:23], v4 offset:9216
    ds_read_b64_tr_b16 v[24:25], v4 offset:16384
    ds_read_b64_tr_b16 v[26:27], v4 offset:17408
    ds_read_b64_tr_b16 v[28:29], v4 offset:24576
    ds_read_b64_tr_b16 v[30:31], v4 offset:25600
    s_waitcnt lgkmcnt(0)
    v_lshlrev_b32 v14, 11, v7
    s_lshl_b32 s60, s3, 3
    s_add_u32 s60, s60, 0x20640
    v_mov_b32 v70, s60
    v_and_b32 v71, 7, v1
    v_lshlrev_b32 v71, 3, v71
    v_add_u32 v71, 0x20640, v71
    v_and_b32 v12, 3, v1
    v_cmp_eq_u32 s[64:65], v12, v6
    s_mov_b32 s60, 0
    s_mov_b64 s[62:63], -1
L_Wg1:
    s_sleep 1
    s_mov_b64 exec, s[62:63]
    buffer_load_dwordx4 v[52:55], v14, s[44:47], s67 offen sc1
    s_add_u32 s60, s60, 1
    s_waitcnt vmcnt(0)
    v_cmp_ne_u32 s[62:63], s4, v55
    s_cmp_gt_u32 s60, 60000
    s_cbranch_scc1 L_Wg
    s_cmp_lg_u64 s[62:63], 0
    s_cbranch_scc1 L_Wg1

L_Wg:
    s_mov_b64 exec, -1
    buffer_load_dwordx4 v[36:39], v9, s[44:47], s69 offen offset:0 sc1
    buffer_load_dwordx4 v[40:43], v9, s[44:47], s69 offen offset:1024 sc1
    buffer_load_dwordx4 v[44:47], v9, s[44:47], s69 offen offset:2048 sc1
    buffer_load_dwordx4 v[48:51], v9, s[44:47], s69 offen offset:3072 sc1
    s_add_u32 s60, s60, 1
    v_subrev_u32 v15, s4, v54
    v_add3_u32 v15, v15, v52, v53
    v_cndmask_b32 v15, 0, v15, s[64:65]
    v_cmp_neq_f32 vcc, 0, v52
    s_cbranch_vccnz L_Wgen

L_Wj:
    v_add_f32_dpp v53, v53, v53 quad_perm:[1,0,3,2] row_mask:0xf bank_mask:0xf
    s_nop 1
    v_add_f32_dpp v53, v53, v53 quad_perm:[2,3,0,1] row_mask:0xf bank_mask:0xf
    s_nop 1
    v_add_f32_dpp v53, v53, v53 row_half_mirror row_mask:0xf bank_mask:0xf
    s_nop 1
    v_add_f32_dpp v53, v53, v53 row_mirror row_mask:0xf bank_mask:0xf
    ds_write_b64 v70, v[52:53]
    s_waitcnt vmcnt(3)
    v_mfma_f32_16x16x32_bf16 v[32:35], v[136:139], v[36:39], 0
    v_add3_u32 v15, v15, v36, v37
    v_add3_u32 v15, v15, v38, v39
    s_waitcnt vmcnt(2)
    v_mfma_f32_16x16x32_bf16 v[32:35], v[140:143], v[40:43], v[32:35]
    v_add3_u32 v15, v15, v40, v41
    v_add3_u32 v15, v15, v42, v43
    s_waitcnt vmcnt(1)
    v_mfma_f32_16x16x32_bf16 v[32:35], v[144:147], v[44:47], v[32:35]
    v_add3_u32 v15, v15, v44, v45
    v_add3_u32 v15, v15, v46, v47
    s_waitcnt vmcnt(0)
    v_mfma_f32_16x16x32_bf16 v[32:35], v[148:151], v[48:51], v[32:35]
    v_add3_u32 v15, v15, v48, v49
    v_add3_u32 v15, v15, v50, v51
    s_nop 1
    v_add_u32_dpp v15, v15, v15 quad_perm:[1,0,3,2] row_mask:0xf bank_mask:0xf
    s_nop 1
    v_add_u32_dpp v15, v15, v15 quad_perm:[2,3,0,1] row_mask:0xf bank_mask:0xf
    v_cvt_pk_bf16_f32 v32, v32, v33
    v_cvt_pk_bf16_f32 v33, v34, v35
    v_add_u32_dpp v15, v15, v15 row_half_mirror row_mask:0xf bank_mask:0xf
    ds_write_b64 v64, v[32:33]
    s_nop 0
    v_add_u32_dpp v15, v15, v15 row_mirror row_mask:0xf bank_mask:0xf
    v_cmp_ne_u32 vcc, 0, v15
    s_cbranch_vccnz L_Wretry
L_Wg_x:

    s_waitcnt lgkmcnt(0)
    s_barrier

    ds_read_b128 v[36:39], v65 offset:2048
    ds_read_b128 v[40:43], v65 offset:2112
    ds_read_b128 v[44:47], v65 offset:2176
    ds_read_b128 v[48:51], v65 offset:2240
    ds_read_b64 v[52:53], v71
    s_waitcnt lgkmcnt(4)
    v_mfma_f32_16x16x32_bf16 v[32:35], v[36:39], v[16:19], 0
    s_waitcnt lgkmcnt(3)
    v_mfma_f32_16x16x32_bf16 v[32:35], v[40:43], v[20:23], v[32:35]
    s_waitcnt lgkmcnt(2)
    v_mfma_f32_16x16x32_bf16 v[32:35], v[44:47], v[24:27], v[32:35]
    s_waitcnt lgkmcnt(1)
    v_mfma_f32_16x16x32_bf16 v[32:35], v[48:51], v[28:31], v[32:35]
    s_waitcnt lgkmcnt(0)
    v_cmp_neq_f32 vcc, 0, v52
    s_cbranch_vccnz L_Wgen2
L_Wj2:
    v_add_f32_dpp v53, v53, v53 quad_perm:[1,0,3,2] row_mask:0xf bank_mask:0xf
    s_nop 1
    v_add_f32_dpp v53, v53, v53 quad_perm:[2,3,0,1] row_mask:0xf bank_mask:0xf
    s_nop 1
    v_add_f32_dpp v53, v53, v53 row_half_mirror row_mask:0xf bank_mask:0xf
    v_add_f32 v32, v32, v33
    v_add_f32 v34, v34, v35
    v_rcp_f32 v67, v53
    v_add_f32 v32, v32, v34

    v_mov_b32 v33, v32
    s_nop 1
    v_permlane16_swap_b32 v32, v33
    v_add_f32 v32, v32, v33
    v_mul_f32 v32, v32, v67
    v_cvt_pk_bf16_f32 v32, v32, v32
    ds_write_b16 v66, v32
    s_waitcnt lgkmcnt(0)
    s_barrier

    ds_read_b128 v[36:39], v5 offset:1280
    ds_read_b128 v[40:43], v5 offset:1344
    ds_read_b128 v[44:47], v5 offset:1408
    ds_read_b128 v[48:51], v5 offset:1472
    s_waitcnt lgkmcnt(3)
    v_mfma_f32_16x16x32_bf16 v[16:19], v[36:39], v[72:75], 0
    v_mfma_f32_16x16x32_bf16 v[20:23], v[36:39], v[88:91], 0
    v_mfma_f32_16x16x32_bf16 v[24:27], v[36:39], v[104:107], 0
    v_mfma_f32_16x16x32_bf16 v[28:31], v[36:39], v[120:123], 0
    s_waitcnt lgkmcnt(2)
    v_mfma_f32_16x16x32_bf16 v[16:19], v[40:43], v[76:79], v[16:19]
    v_mfma_f32_16x16x32_bf16 v[20:23], v[40:43], v[92:95], v[20:23]
    v_mfma_f32_16x16x32_bf16 v[24:27], v[40:43], v[108:111], v[24:27]
    v_mfma_f32_16x16x32_bf16 v[28:31], v[40:43], v[124:127], v[28:31]
    s_waitcnt lgkmcnt(1)
    v_mfma_f32_16x16x32_bf16 v[16:19], v[44:47], v[80:83], v[16:19]
    v_mfma_f32_16x16x32_bf16 v[20:23], v[44:47], v[96:99], v[20:23]
    v_mfma_f32_16x16x32_bf16 v[24:27], v[44:47], v[112:115], v[24:27]
    v_mfma_f32_16x16x32_bf16 v[28:31], v[44:47], v[128:131], v[28:31]
    s_waitcnt lgkmcnt(0)
    v_mfma_f32_16x16x32_bf16 v[16:19], v[48:51], v[84:87], v[16:19]
    v_mfma_f32_16x16x32_bf16 v[20:23], v[48:51], v[100:103], v[20:23]
    v_mfma_f32_16x16x32_bf16 v[24:27], v[48:51], v[116:119], v[24:27]
    v_mfma_f32_16x16x32_bf16 v[28:31], v[48:51], v[132:135], v[28:31]
    s_nop 5
    v_cndmask_b32 v16, v16, v20, s[52:53]
    v_cndmask_b32 v16, v16, v24, s[54:55]
    v_cndmask_b32 v16, v16, v28, s[56:57]
    buffer_store_dword v16, v11, s[44:47], s58 offen sc1

    s_endpgm
L_A:
    s_mov_b32 s44, s38
    s_mov_b32 s45, s39
    s_mov_b32 s46, 0x520000
    s_mov_b32 s47, 0x20000
    s_mov_b32 s52, 0xffff0000
    s_mov_b32 s53, 0
    s_mov_b32 s54, 0
    s_mov_b32 s55, 0x0000ffff
    s_mov_b32 s56, 0
    s_mov_b32 s57, 0xffff0000

    s_mov_b32 s40, s18
    s_mov_b32 s41, s19
    s_mov_b32 s42, 0x2000000
    s_mov_b32 s43, 0x20000
    v_mbcnt_lo_u32_b32 v3, -1, 0
    v_mbcnt_hi_u32_b32 v3, -1, v3
    v_lshrrev_b32 v0, 4, v3
    v_and_b32 v3, 15, v3
    v_lshlrev_b32 v3, 4, v3
    v_mul_u32_u24 v0, 0x440, v0
    v_xor_b32 v3, v3, v0
    v_xor_b32 v0, 32, v3

    s_and_b32 s59, s2, 7
    s_lshl_b32 s59, s59, 4
    s_lshr_b32 s8, s2, 3
    s_add_u32 s59, s59, s8
    s_lshl_b32 s8, s59, 18
    s_cmp_ge_u32 s3, 4
    s_cbranch_scc1 L_As
    s_lshl_b32 s9, s3, 14
    s_add_u32 s8, s8, s9
    s_lshl_b32 s10, s3, 8
    s_or_b32 s66, s8, s10
    s_lshl_b32 s10, s3, 10
    s_or_b32 s67, s9, s10
    s_mov_b32 s15, 0
    v_mov_b32 v10, 0
    v_mov_b32 v11, 0

L_Apass:

    s_xor_b32 m0, s67, 0x0
    s_xor_b32 s10, s66, 0x0
    buffer_load_dwordx4 v3, s[40:43], s10 offen nt lds
    v_mbcnt_lo_u32_b32 v1, -1, 0
    v_mbcnt_hi_u32_b32 v1, -1, v1
    v_lshrrev_b32 v16, 4, v1
    v_and_b32 v17, 15, v1
    v_lshlrev_b32 v5, 4, v1
    v_add_u32 v5, 0x20000, v5
    v_lshlrev_b32 v18, 4, v16
    v_xor_b32 v32, v5, v18
    v_xor_b32 v33, 64, v32
    s_lshr_b32 s10, s3, 1
    s_lshl_b32 s10, s10, 11
    s_and_b32 s11, s3, 1
    s_lshl_b32 s11, s11, 9
    s_add_u32 s10, s10, s11
    s_add_u32 s10, s10, 0x20000
    v_lshrrev_b32 v18, 1, v16
    v_lshlrev_b32 v19, 8, v18
    v_lshl_add_u32 v19, v17, 4, v19
    v_and_b32 v20, 1, v16
    v_lshl_add_u32 v19, v20, 3, v19
    v_add_u32 v4, s10, v19
    v_lshrrev_b32 v21, 2, v17
    v_bfe_u32 v22, v1, 1, 1
    v_lshl_add_u32 v22, v20, 1, v22
    v_lshl_add_u32 v22, v21, 2, v22
    v_lshlrev_b32 v22, 4, v22
    v_lshl_add_u32 v22, v21, 8, v22
    v_lshl_add_u32 v22, v20, 13, v22
    v_lshl_add_u32 v22, v18, 14, v22
    v_and_b32 v23, 1, v1
    v_lshl_add_u32 v22, v23, 3, v22
    s_lshr_b32 s10, s3, 1
    s_lshl_b32 s10, s10, 10
    s_and_b32 s11, s3, 1
    s_lshl_b32 s11, s11, 7
    s_or_b32 s10, s10, s11
    v_xor_b32 v2, s10, v22
    v_and_b32 v22, 3, v17
    v_and_b32 v23, 2, v21
    v_xor_b32 v23, v23, v16
    v_lshl_add_u32 v23, v22, 2, v23
    v_lshlrev_b32 v23, 4, v23
    v_lshl_add_u32 v23, v22, 8, v23
    v_lshl_add_u32 v23, v21, 12, v23
    v_add_u32 v12, s9, v23
    v_xor_b32 v13, 64, v12
    v_xor_b32 v14, 0x80, v12
    v_xor_b32 v15, 0xc0, v12
    v_mov_b32 v6, 0
    v_mov_b32 v7, 0
    v_mov_b32 v8, 0xff800000
    v_mov_b32 v9, 0xff800000

    v_mov_b32 v16, v10
    v_mov_b32 v17, v10
    v_mov_b32 v18, v10
    v_mov_b32 v19, v10
    v_mov_b32 v20, v11
    v_mov_b32 v21, v11
    v_mov_b32 v22, v11
    v_mov_b32 v23, v11
    v_mov_b32 v24, v10
    v_mov_b32 v25, v10
    v_mov_b32 v26, v10
    v_mov_b32 v27, v10
    v_mov_b32 v28, v11
    v_mov_b32 v29, v11
    v_mov_b32 v30, v11
    v_mov_b32 v31, v11
    s_waitcnt vmcnt(0)
    s_xor_b32 m0, s67, 0x400
    s_xor_b32 s10, s66, 0x100
    buffer_load_dwordx4 v3, s[40:43], s10 offen nt lds
    s_waitcnt vmcnt(0)
    s_xor_b32 m0, s67, 0x800
    s_xor_b32 s10, s66, 0x200
    buffer_load_dwordx4 v3, s[40:43], s10 offen nt lds
    s_xor_b32 m0, s67, 0xc00
    s_xor_b32 s10, s66, 0x300
    buffer_load_dwordx4 v3, s[40:43], s10 offen nt lds
    s_xor_b32 m0, s67, 0x1000
    s_xor_b32 s10, s66, 0x1000
    buffer_load_dwordx4 v3, s[40:43], s10 offen nt lds
    s_xor_b32 m0, s67, 0x1400
    s_xor_b32 s10, s66, 0x1100
    buffer_load_dwordx4 v3, s[40:43], s10 offen nt lds
    s_xor_b32 m0, s67, 0x1800
    s_xor_b32 s10, s66, 0x1200
    buffer_load_dwordx4 v3, s[40:43], s10 offen nt lds
    s_xor_b32 m0, s67, 0x1c00
    s_xor_b32 s10, s66, 0x1300
    buffer_load_dwordx4 v3, s[40:43], s10 offen nt lds
    s_xor_b32 m0, s67, 0x2000
    s_xor_b32 s10, s66, 0x2000
    buffer_load_dwordx4 v0, s[40:43], s10 offen nt lds
    s_xor_b32 m0, s67, 0x2400
    s_xor_b32 s10, s66, 0x2100
    buffer_load_dwordx4 v0, s[40:43], s10 offen nt lds
    s_waitcnt vmcnt(7)
    s_xor_b32 m0, s67, 0x2800
    s_xor_b32 s10, s66, 0x2200
    buffer_load_dwordx4 v0, s[40:43], s10 offen nt lds
    s_waitcnt vmcnt(7)
    s_xor_b32 m0, s67, 0x2c00
    s_xor_b32 s10, s66, 0x2300
    buffer_load_dwordx4 v0, s[40:43], s10 offen nt lds
    s_waitcnt vmcnt(7)
    s_xor_b32 m0, s67, 0x3000
    s_xor_b32 s10, s66, 0x3000
    buffer_load_dwordx4 v0, s[40:43], s10 offen nt lds
    s_waitcnt vmcnt(7)
    s_xor_b32 m0, s67, 0x3400
    s_xor_b32 s10, s66, 0x3100
    buffer_load_dwordx4 v0, s[40:43], s10 offen nt lds
    s_waitcnt vmcnt(7)
    s_xor_b32 m0, s67, 0x3800
    s_xor_b32 s10, s66, 0x3200
    buffer_load_dwordx4 v0, s[40:43], s10 offen nt lds
    s_waitcnt vmcnt(7)
    s_xor_b32 m0, s67, 0x3c00
    s_xor_b32 s10, s66, 0x3300
    buffer_load_dwordx4 v0, s[40:43], s10 offen nt lds
    s_waitcnt vmcnt(7)
    s_xor_b32 m0, s67, 0x10000
    s_xor_b32 s10, s66, 0x10000
    buffer_load_dwordx4 v3, s[40:43], s10 offen nt lds
    s_waitcnt vmcnt(7)
    s_xor_b32 m0, s67, 0x10400
    s_xor_b32 s10, s66, 0x10100
    buffer_load_dwordx4 v3, s[40:43], s10 offen nt lds
    s_waitcnt vmcnt(7)
    s_xor_b32 m0, s67, 0x10800
    s_xor_b32 s10, s66, 0x10200
    buffer_load_dwordx4 v3, s[40:43], s10 offen nt lds
    s_waitcnt vmcnt(7)
    s_xor_b32 m0, s67, 0x10c00
    s_xor_b32 s10, s66, 0x10300
    buffer_load_dwordx4 v3, s[40:43], s10 offen nt lds
    s_waitcnt vmcnt(4)
    ds_read_b128 v[64:67], v12 offset:0
    ds_read_b128 v[68:71], v13 offset:0
    ds_read_b128 v[72:75], v14 offset:0
    ds_read_b128 v[76:79], v15 offset:0
    ds_read_b128 v[80:83], v12 offset:1024
    ds_read_b128 v[84:87], v13 offset:1024
    ds_read_b128 v[88:91], v14 offset:1024
    ds_read_b128 v[92:95], v15 offset:1024
    ds_read_b128 v[96:99], v12 offset:2048
    ds_read_b128 v[100:103], v13 offset:2048
    ds_read_b128 v[104:107], v14 offset:2048
    ds_read_b128 v[108:111], v15 offset:2048
    ds_read_b128 v[112:115], v12 offset:3072
    ds_read_b128 v[116:119], v13 offset:3072
    ds_read_b128 v[120:123], v14 offset:3072
    s_waitcnt lgkmcnt(14)
    ds_read_b128 v[124:127], v15 offset:3072
    s_waitcnt vmcnt(0)
    s_barrier
    v_mov_b32 v35, 0
    global_load_dword v34, v35, s[36:37] sc1
    s_cmp_eq_u32 s15, 0
    s_cbranch_scc1 L_Anr
    s_xor_b32 m0, s67, 0x11000
    s_xor_b32 s10, s66, 0x11000
    buffer_load_dwordx4 v3, s[40:43], s10 offen nt lds
    s_xor_b32 m0, s67, 0x11400
    s_xor_b32 s10, s66, 0x11100
    buffer_load_dwordx4 v3, s[40:43], s10 offen nt lds
    s_xor_b32 m0, s67, 0x11800
    s_xor_b32 s10, s66, 0x11200
    buffer_load_dwordx4 v3, s[40:43], s10 offen nt lds
    s_xor_b32 m0, s67, 0x11c00
    s_xor_b32 s10, s66, 0x11300
    buffer_load_dwordx4 v3, s[40:43], s10 offen nt lds
    s_xor_b32 m0, s67, 0x12000
    s_xor_b32 s10, s66, 0x12000
    buffer_load_dwordx4 v0, s[40:43], s10 offen nt lds
    s_xor_b32 m0, s67, 0x12400
    s_xor_b32 s10, s66, 0x12100
    buffer_load_dwordx4 v0, s[40:43], s10 offen nt lds
    s_xor_b32 m0, s67, 0x12800
    s_xor_b32 s10, s66, 0x12200
    buffer_load_dwordx4 v0, s[40:43], s10 offen nt lds
    s_xor_b32 m0, s67, 0x12c00
    s_xor_b32 s10, s66, 0x12300
    buffer_load_dwordx4 v0, s[40:43], s10 offen nt lds
    s_xor_b32 m0, s67, 0x13000
    s_xor_b32 s10, s66, 0x13000
    buffer_load_dwordx4 v0, s[40:43], s10 offen nt lds
    s_xor_b32 m0, s67, 0x13400
    s_xor_b32 s10, s66, 0x13100
    buffer_load_dwordx4 v0, s[40:43], s10 offen nt lds
    s_xor_b32 m0, s67, 0x13800
    s_xor_b32 s10, s66, 0x13200
    buffer_load_dwordx4 v0, s[40:43], s10 offen nt lds
    s_xor_b32 m0, s67, 0x13c00
    s_xor_b32 s10, s66, 0x13300
    buffer_load_dwordx4 v0, s[40:43], s10 offen nt lds
    s_waitcnt vmcnt(0)
L_Anr:
    s_waitcnt lgkmcnt(14)
    ds_read_b64_tr_b16 v[48:49], v2 offset:0
    s_waitcnt lgkmcnt(14)
    ds_read_b64_tr_b16 v[50:51], v2 offset:4096
    s_waitcnt lgkmcnt(14)
    ds_read_b64_tr_b16 v[52:53], v2 offset:32768
    s_waitcnt lgkmcnt(14)
    ds_read_b64_tr_b16 v[54:55], v2 offset:36864
    v_xor_b32 v2, 0x20, v2
    s_waitcnt lgkmcnt(14)
    ds_read_b64_tr_b16 v[56:57], v2 offset:0
    s_waitcnt lgkmcnt(14)
    ds_read_b64_tr_b16 v[58:59], v2 offset:4096
    s_waitcnt lgkmcnt(14)
    ds_read_b64_tr_b16 v[60:61], v2 offset:32768
    s_waitcnt lgkmcnt(14)
    ds_read_b64_tr_b16 v[62:63], v2 offset:36864
    v_xor_b32 v12, 0x10000, v12
    s_waitcnt lgkmcnt(14)
    ds_read_b128 v[36:39], v12 offset:0
    v_xor_b32 v13, 0x10000, v13
    s_waitcnt lgkmcnt(14)
    ds_read_b128 v[40:43], v13 offset:0
    v_xor_b32 v14, 0x10000, v14
    s_waitcnt lgkmcnt(14)
    ds_read_b128 v[44:47], v14 offset:0
    v_and_b32 v0, 3, v1
    v_lshlrev_b32 v0, 2, v0
    v_add_u32 v0, 0x23000, v0
    s_lshl_b32 s10, s3, 2
    s_add_u32 s10, s10, 0x23000
    v_mov_b32 v3, s10
    s_mov_b32 s62, 0

    s_waitcnt lgkmcnt(0)
    s_barrier
    s_cmp_lg_u32 s15, 0
    s_cbranch_scc1 L_Anoq
    ds_read_b128 v[128:131], v32 offset:0
    ds_read_b128 v[192:195], v32 offset:16384
    ds_read_b128 v[132:135], v33 offset:1024
    ds_read_b128 v[196:199], v33 offset:17408
    ds_read_b128 v[136:139], v32 offset:2048
    ds_read_b128 v[200:203], v32 offset:18432
    ds_read_b128 v[140:143], v33 offset:3072
    ds_read_b128 v[204:207], v33 offset:19456
    ds_read_b128 v[144:147], v32 offset:4096
    ds_read_b128 v[208:211], v32 offset:20480
    s_waitcnt lgkmcnt(8)
    v_mfma_f32_16x16x32_bf16 v[24:27], v[64:67], v[128:131], v[24:27]
    v_mfma_f32_16x16x32_bf16 v[28:31], v[64:67], v[192:195], v[28:31]
    ds_read_b128 v[148:151], v33 offset:5120
    ds_read_b128 v[212:215], v33 offset:21504
    s_waitcnt lgkmcnt(8)
    v_mfma_f32_16x16x32_bf16 v[24:27], v[68:71], v[132:135], v[24:27]
    v_mfma_f32_16x16x32_bf16 v[28:31], v[68:71], v[196:199], v[28:31]
    ds_read_b128 v[152:155], v32 offset:6144
    ds_read_b128 v[216:219], v32 offset:22528
    v_mfma_f32_16x16x32_bf16 v[16:19], v[36:39], v[128:131], v[16:19]
    v_mfma_f32_16x16x32_bf16 v[20:23], v[36:39], v[192:195], v[20:23]
    s_waitcnt lgkmcnt(8)
    v_mfma_f32_16x16x32_bf16 v[24:27], v[72:75], v[136:139], v[24:27]
    v_mfma_f32_16x16x32_bf16 v[28:31], v[72:75], v[200:203], v[28:31]
    ds_read_b128 v[156:159], v33 offset:7168
    ds_read_b128 v[220:223], v33 offset:23552
    s_waitcnt lgkmcnt(8)
    v_mfma_f32_16x16x32_bf16 v[24:27], v[76:79], v[140:143], v[24:27]
    v_mfma_f32_16x16x32_bf16 v[28:31], v[76:79], v[204:207], v[28:31]
    ds_read_b128 v[160:163], v32 offset:8192
    ds_read_b128 v[224:227], v32 offset:24576
    v_mfma_f32_16x16x32_bf16 v[16:19], v[40:43], v[132:135], v[16:19]
    v_mfma_f32_16x16x32_bf16 v[20:23], v[40:43], v[196:199], v[20:23]
    s_waitcnt lgkmcnt(8)
    v_mfma_f32_16x16x32_bf16 v[24:27], v[80:83], v[144:147], v[24:27]
    v_mfma_f32_16x16x32_bf16 v[28:31], v[80:83], v[208:211], v[28:31]
    ds_read_b128 v[164:167], v33 offset:9216
    ds_read_b128 v[228:231], v33 offset:25600
    v_xor_b32 v15, 0x10000, v15
    ds_read_b128 v[76:79], v15 offset:0
    s_waitcnt lgkmcnt(9)
    v_mfma_f32_16x16x32_bf16 v[24:27], v[84:87], v[148:151], v[24:27]
    v_mfma_f32_16x16x32_bf16 v[28:31], v[84:87], v[212:215], v[28:31]
    ds_read_b128 v[168:171], v32 offset:10240
    ds_read_b128 v[232:235], v32 offset:26624
    ds_read_b128 v[80:83], v12 offset:1024
    v_mfma_f32_16x16x32_bf16 v[16:19], v[44:47], v[136:139], v[16:19]
    v_mfma_f32_16x16x32_bf16 v[20:23], v[44:47], v[200:203], v[20:23]
    s_waitcnt lgkmcnt(10)
    v_mfma_f32_16x16x32_bf16 v[24:27], v[88:91], v[152:155], v[24:27]
    v_mfma_f32_16x16x32_bf16 v[28:31], v[88:91], v[216:219], v[28:31]
    ds_read_b128 v[172:175], v33 offset:11264
    ds_read_b128 v[236:239], v33 offset:27648
    ds_read_b128 v[84:87], v13 offset:1024
    s_waitcnt lgkmcnt(11)
    v_mfma_f32_16x16x32_bf16 v[24:27], v[92:95], v[156:159], v[24:27]
    v_mfma_f32_16x16x32_bf16 v[28:31], v[92:95], v[220:223], v[28:31]
    ds_read_b128 v[176:179], v32 offset:12288
    ds_read_b128 v[240:243], v32 offset:28672
    ds_read_b128 v[88:91], v14 offset:1024
    s_waitcnt lgkmcnt(9)
    v_mfma_f32_16x16x32_bf16 v[16:19], v[76:79], v[140:143], v[16:19]
    v_mfma_f32_16x16x32_bf16 v[20:23], v[76:79], v[204:207], v[20:23]
    v_mfma_f32_16x16x32_bf16 v[24:27], v[96:99], v[160:163], v[24:27]
    v_mfma_f32_16x16x32_bf16 v[28:31], v[96:99], v[224:227], v[28:31]
    ds_read_b128 v[180:183], v33 offset:13312
    ds_read_b128 v[244:247], v33 offset:29696
    ds_read_b128 v[92:95], v15 offset:1024
    v_mfma_f32_16x16x32_bf16 v[24:27], v[100:103], v[164:167], v[24:27]
    v_mfma_f32_16x16x32_bf16 v[28:31], v[100:103], v[228:231], v[28:31]
    ds_read_b128 v[184:187], v32 offset:14336
    ds_read_b128 v[248:251], v32 offset:30720
    ds_read_b128 v[96:99], v12 offset:2048
    s_waitcnt lgkmcnt(12)
    v_mfma_f32_16x16x32_bf16 v[16:19], v[80:83], v[144:147], v[16:19]
    v_mfma_f32_16x16x32_bf16 v[20:23], v[80:83], v[208:211], v[20:23]
    v_mfma_f32_16x16x32_bf16 v[24:27], v[104:107], v[168:171], v[24:27]
    v_mfma_f32_16x16x32_bf16 v[28:31], v[104:107], v[232:235], v[28:31]
    ds_read_b128 v[188:191], v33 offset:15360
    ds_read_b128 v[252:255], v33 offset:31744
    ds_read_b128 v[100:103], v13 offset:2048
    s_waitcnt lgkmcnt(13)
    v_mfma_f32_16x16x32_bf16 v[24:27], v[108:111], v[172:175], v[24:27]
    v_mfma_f32_16x16x32_bf16 v[28:31], v[108:111], v[236:239], v[28:31]
    ds_read_b128 v[104:107], v14 offset:2048
    s_waitcnt lgkmcnt(13)
    v_mfma_f32_16x16x32_bf16 v[16:19], v[84:87], v[148:151], v[16:19]
    v_mfma_f32_16x16x32_bf16 v[20:23], v[84:87], v[212:215], v[20:23]
    s_waitcnt lgkmcnt(11)
    v_mfma_f32_16x16x32_bf16 v[24:27], v[112:115], v[176:179], v[24:27]
    v_mfma_f32_16x16x32_bf16 v[28:31], v[112:115], v[240:243], v[28:31]
    ds_read_b128 v[108:111], v15 offset:2048
    s_waitcnt lgkmcnt(9)
    v_mfma_f32_16x16x32_bf16 v[24:27], v[116:119], v[180:183], v[24:27]
    v_mfma_f32_16x16x32_bf16 v[28:31], v[116:119], v[244:247], v[28:31]
    ds_read_b128 v[112:115], v12 offset:3072
    v_mfma_f32_16x16x32_bf16 v[16:19], v[88:91], v[152:155], v[16:19]
    v_mfma_f32_16x16x32_bf16 v[20:23], v[88:91], v[216:219], v[20:23]
    s_waitcnt lgkmcnt(7)
    v_mfma_f32_16x16x32_bf16 v[24:27], v[120:123], v[184:187], v[24:27]
    v_mfma_f32_16x16x32_bf16 v[28:31], v[120:123], v[248:251], v[28:31]
    ds_read_b128 v[116:119], v13 offset:3072
    s_waitcnt lgkmcnt(5)
    v_mfma_f32_16x16x32_bf16 v[24:27], v[124:127], v[188:191], v[24:27]
    v_mfma_f32_16x16x32_bf16 v[28:31], v[124:127], v[252:255], v[28:31]
    ds_read_b128 v[120:123], v14 offset:3072
    v_mfma_f32_16x16x32_bf16 v[16:19], v[92:95], v[156:159], v[16:19]
    v_mfma_f32_16x16x32_bf16 v[20:23], v[92:95], v[220:223], v[20:23]
    s_waitcnt lgkmcnt(0)
    s_branch L_Aq2
L_Anoq:
    s_waitcnt vmcnt(0)
    s_add_u32 s10, s58, 24
    v_mov_b32 v1, s10
    ds_write_b32 v3, v1 offset:32
    v_mfma_f32_16x16x32_bf16 v[24:27], v[64:67], v[128:131], v[24:27]
    v_mfma_f32_16x16x32_bf16 v[28:31], v[64:67], v[192:195], v[28:31]
    v_mfma_f32_16x16x32_bf16 v[24:27], v[68:71], v[132:135], v[24:27]
    v_mfma_f32_16x16x32_bf16 v[28:31], v[68:71], v[196:199], v[28:31]
    v_mfma_f32_16x16x32_bf16 v[16:19], v[36:39], v[128:131], v[16:19]
    v_mfma_f32_16x16x32_bf16 v[20:23], v[36:39], v[192:195], v[20:23]
    v_mfma_f32_16x16x32_bf16 v[24:27], v[72:75], v[136:139], v[24:27]
    v_mfma_f32_16x16x32_bf16 v[28:31], v[72:75], v[200:203], v[28:31]
    v_mfma_f32_16x16x32_bf16 v[24:27], v[76:79], v[140:143], v[24:27]
    v_mfma_f32_16x16x32_bf16 v[28:31], v[76:79], v[204:207], v[28:31]
    v_mfma_f32_16x16x32_bf16 v[16:19], v[40:43], v[132:135], v[16:19]
    v_mfma_f32_16x16x32_bf16 v[20:23], v[40:43], v[196:199], v[20:23]
    v_mfma_f32_16x16x32_bf16 v[24:27], v[80:83], v[144:147], v[24:27]
    v_mfma_f32_16x16x32_bf16 v[28:31], v[80:83], v[208:211], v[28:31]
    v_xor_b32 v15, 0x10000, v15
    ds_read_b128 v[76:79], v15 offset:0
    v_mfma_f32_16x16x32_bf16 v[24:27], v[84:87], v[148:151], v[24:27]
    v_mfma_f32_16x16x32_bf16 v[28:31], v[84:87], v[212:215], v[28:31]
    ds_read_b128 v[80:83], v12 offset:1024
    v_mfma_f32_16x16x32_bf16 v[16:19], v[44:47], v[136:139], v[16:19]
    v_mfma_f32_16x16x32_bf16 v[20:23], v[44:47], v[200:203], v[20:23]
    v_mfma_f32_16x16x32_bf16 v[24:27], v[88:91], v[152:155], v[24:27]
    v_mfma_f32_16x16x32_bf16 v[28:31], v[88:91], v[216:219], v[28:31]
    ds_read_b128 v[84:87], v13 offset:1024
    v_mfma_f32_16x16x32_bf16 v[24:27], v[92:95], v[156:159], v[24:27]
    v_mfma_f32_16x16x32_bf16 v[28:31], v[92:95], v[220:223], v[28:31]
    ds_read_b128 v[88:91], v14 offset:1024
    s_waitcnt lgkmcnt(3)
    v_mfma_f32_16x16x32_bf16 v[16:19], v[76:79], v[140:143], v[16:19]
    v_mfma_f32_16x16x32_bf16 v[20:23], v[76:79], v[204:207], v[20:23]
    v_mfma_f32_16x16x32_bf16 v[24:27], v[96:99], v[160:163], v[24:27]
    v_mfma_f32_16x16x32_bf16 v[28:31], v[96:99], v[224:227], v[28:31]
    ds_read_b128 v[92:95], v15 offset:1024
    v_mfma_f32_16x16x32_bf16 v[24:27], v[100:103], v[164:167], v[24:27]
    v_mfma_f32_16x16x32_bf16 v[28:31], v[100:103], v[228:231], v[28:31]
    ds_read_b128 v[96:99], v12 offset:2048
    s_waitcnt lgkmcnt(4)
    v_mfma_f32_16x16x32_bf16 v[16:19], v[80:83], v[144:147], v[16:19]
    v_mfma_f32_16x16x32_bf16 v[20:23], v[80:83], v[208:211], v[20:23]
    v_mfma_f32_16x16x32_bf16 v[24:27], v[104:107], v[168:171], v[24:27]
    v_mfma_f32_16x16x32_bf16 v[28:31], v[104:107], v[232:235], v[28:31]
    ds_read_b128 v[100:103], v13 offset:2048
    v_mfma_f32_16x16x32_bf16 v[24:27], v[108:111], v[172:175], v[24:27]
    v_mfma_f32_16x16x32_bf16 v[28:31], v[108:111], v[236:239], v[28:31]
    ds_read_b128 v[104:107], v14 offset:2048
    s_waitcnt lgkmcnt(5)
    v_mfma_f32_16x16x32_bf16 v[16:19], v[84:87], v[148:151], v[16:19]
    v_mfma_f32_16x16x32_bf16 v[20:23], v[84:87], v[212:215], v[20:23]
    v_mfma_f32_16x16x32_bf16 v[24:27], v[112:115], v[176:179], v[24:27]
    v_mfma_f32_16x16x32_bf16 v[28:31], v[112:115], v[240:243], v[28:31]
    ds_read_b128 v[108:111], v15 offset:2048
    v_mfma_f32_16x16x32_bf16 v[24:27], v[116:119], v[180:183], v[24:27]
    v_mfma_f32_16x16x32_bf16 v[28:31], v[116:119], v[244:247], v[28:31]
    ds_read_b128 v[112:115], v12 offset:3072
    s_waitcnt lgkmcnt(6)
    v_mfma_f32_16x16x32_bf16 v[16:19], v[88:91], v[152:155], v[16:19]
    v_mfma_f32_16x16x32_bf16 v[20:23], v[88:91], v[216:219], v[20:23]
    v_mfma_f32_16x16x32_bf16 v[24:27], v[120:123], v[184:187], v[24:27]
    v_mfma_f32_16x16x32_bf16 v[28:31], v[120:123], v[248:251], v[28:31]
    ds_read_b128 v[116:119], v13 offset:3072
    v_mfma_f32_16x16x32_bf16 v[24:27], v[124:127], v[188:191], v[24:27]
    v_mfma_f32_16x16x32_bf16 v[28:31], v[124:127], v[252:255], v[28:31]
    ds_read_b128 v[120:123], v14 offset:3072
    s_waitcnt lgkmcnt(7)
    v_mfma_f32_16x16x32_bf16 v[16:19], v[92:95], v[156:159], v[16:19]
    v_mfma_f32_16x16x32_bf16 v[20:23], v[92:95], v[220:223], v[20:23]
    s_waitcnt lgkmcnt(0)
L_Aq2:
    s_waitcnt vmcnt(0)
    v_readfirstlane_b32 s58, v34
    s_lshl_b32 s10, s15, 4
    s_add_u32 s57, s58, s10
    s_barrier

    ds_read_b128 v[124:127], v15 offset:3072
    v_mfma_f32_16x16x32_bf16 v[16:19], v[96:99], v[160:163], v[16:19]
    v_exp_f32 v36, v24
    v_exp_f32 v37, v25
    v_mfma_f32_16x16x32_bf16 v[20:23], v[96:99], v[224:227], v[20:23]
    v_exp_f32 v38, v26
    v_exp_f32 v39, v27
    v_mfma_f32_16x16x32_bf16 v[16:19], v[100:103], v[164:167], v[16:19]
    v_cvt_pk_bf16_f32 v32, v36, v37
    v_cvt_pk_bf16_f32 v33, v38, v39
    ds_write_b64 v4, v[32:33] offset:0
    v_mfma_f32_16x16x32_bf16 v[20:23], v[100:103], v[228:231], v[20:23]
    v_exp_f32 v40, v28
    v_exp_f32 v41, v29
    v_mfma_f32_16x16x32_bf16 v[16:19], v[104:107], v[168:171], v[16:19]
    v_exp_f32 v42, v30
    v_exp_f32 v43, v31
    v_mfma_f32_16x16x32_bf16 v[20:23], v[104:107], v[232:235], v[20:23]
    v_cvt_pk_bf16_f32 v34, v40, v41
    v_cvt_pk_bf16_f32 v35, v42, v43
    ds_write_b64 v4, v[34:35] offset:1024
    v_mfma_f32_16x16x32_bf16 v[16:19], v[108:111], v[172:175], v[16:19]
    s_add_u32 s63, s57, 0
    v_mov_b32 v1, s63
    ds_write_b32 v3, v1
    v_mfma_f32_16x16x32_bf16 v[20:23], v[108:111], v[236:239], v[20:23]
    v_add_f32 v36, v36, v37
    v_add_f32 v38, v38, v39
    v_max3_f32 v8, v8, v24, v25
    v_add_f32 v6, v6, v36
    v_max3_f32 v8, v8, v26, v27
    v_add_f32 v6, v6, v38
    v_mfma_f32_16x16x32_bf16 v[16:19], v[112:115], v[176:179], v[16:19]
    v_add_f32 v40, v40, v41
    v_add_f32 v42, v42, v43
    v_max3_f32 v9, v9, v28, v29
    v_add_f32 v7, v7, v40
    v_max3_f32 v9, v9, v30, v31
    v_add_f32 v7, v7, v42
    v_mfma_f32_16x16x32_bf16 v[20:23], v[112:115], v[240:243], v[20:23]
    ds_read_b32 v1, v0
    v_mfma_f32_16x16x32_bf16 v[16:19], v[116:119], v[180:183], v[16:19]
    v_xor_b32 v2, 0x60, v2
    ds_read_b64_tr_b16 v[24:25], v2 offset:0
    ds_read_b64_tr_b16 v[26:27], v2 offset:4096
    v_mfma_f32_16x16x32_bf16 v[20:23], v[116:119], v[244:247], v[20:23]
    ds_read_b64_tr_b16 v[28:29], v2 offset:32768
    ds_read_b64_tr_b16 v[30:31], v2 offset:36864
    v_mfma_f32_16x16x32_bf16 v[16:19], v[120:123], v[184:187], v[16:19]
    s_waitcnt lgkmcnt(4)
    v_subrev_u32 v1, s63, v1
    v_cmp_lt_u32 vcc, 7, v1
    s_cbranch_vccnz L_Apc_1
L_Apc_1b:
    ds_read_b128 v[32:35], v5 offset:0
    ds_read_b128 v[36:39], v5 offset:1024
    ds_read_b128 v[40:43], v5 offset:2048
    ds_read_b128 v[44:47], v5 offset:3072
    v_mfma_f32_16x16x32_bf16 v[20:23], v[120:123], v[248:251], v[20:23]
    v_mfma_f32_16x16x32_bf16 v[16:19], v[124:127], v[188:191], v[16:19]
    v_mfma_f32_16x16x32_bf16 v[20:23], v[124:127], v[252:255], v[20:23]
    s_waitcnt lgkmcnt(3)
    v_mfma_f32_16x16x32_bf16 v[64:67], v[32:35], v[48:51], 0
    s_waitcnt lgkmcnt(2)
    v_mfma_f32_16x16x32_bf16 v[96:99], v[36:39], v[48:51], 0
    s_waitcnt lgkmcnt(1)
    v_mfma_f32_16x16x32_bf16 v[64:67], v[40:43], v[52:55], v[64:67]
    s_waitcnt lgkmcnt(0)
    v_mfma_f32_16x16x32_bf16 v[96:99], v[44:47], v[52:55], v[96:99]
    v_max3_f32 v8, v8, v16, v17
    v_max3_f32 v8, v8, v18, v19
    v_mfma_f32_16x16x32_bf16 v[68:71], v[32:35], v[56:59], 0
    v_xor_b32 v2, 0x20, v2
    ds_read_b64_tr_b16 v[48:49], v2 offset:0
    v_exp_f32 v16, v16
    v_mfma_f32_16x16x32_bf16 v[100:103], v[36:39], v[56:59], 0
    ds_read_b64_tr_b16 v[50:51], v2 offset:4096
    v_exp_f32 v17, v17
    v_mfma_f32_16x16x32_bf16 v[68:71], v[40:43], v[60:63], v[68:71]
    ds_read_b64_tr_b16 v[52:53], v2 offset:32768
    v_exp_f32 v18, v18
    v_mfma_f32_16x16x32_bf16 v[100:103], v[44:47], v[60:63], v[100:103]
    ds_read_b64_tr_b16 v[54:55], v2 offset:36864
    v_exp_f32 v19, v19
    v_mfma_f32_16x16x32_bf16 v[72:75], v[32:35], v[24:27], 0
    v_xor_b32 v2, 0x860, v2
    ds_read_b64_tr_b16 v[56:57], v2 offset:0
    v_add_f32 v6, v6, v16
    v_cvt_pk_bf16_f32 v16, v16, v17
    v_mfma_f32_16x16x32_bf16 v[104:107], v[36:39], v[24:27], 0
    ds_read_b64_tr_b16 v[58:59], v2 offset:4096
    v_add_f32 v6, v6, v17
    v_cvt_pk_bf16_f32 v17, v18, v19
    v_mfma_f32_16x16x32_bf16 v[72:75], v[40:43], v[28:31], v[72:75]
    ds_read_b64_tr_b16 v[60:61], v2 offset:32768
    v_add_f32 v18, v18, v19
    ds_write_b64 v4, v[16:17] offset:4096
    v_mfma_f32_16x16x32_bf16 v[104:107], v[44:47], v[28:31], v[104:107]
    ds_read_b64_tr_b16 v[62:63], v2 offset:36864
    v_add_f32 v6, v6, v18
    s_waitcnt lgkmcnt(7)
    v_mfma_f32_16x16x32_bf16 v[76:79], v[32:35], v[48:51], 0
    v_xor_b32 v2, 0x20, v2
    ds_read_b64_tr_b16 v[24:25], v2 offset:0
    v_max3_f32 v9, v9, v20, v21
    v_max3_f32 v9, v9, v22, v23
    v_mfma_f32_16x16x32_bf16 v[108:111], v[36:39], v[48:51], 0
    ds_read_b64_tr_b16 v[26:27], v2 offset:4096
    v_exp_f32 v20, v20
    s_waitcnt lgkmcnt(7)
    v_mfma_f32_16x16x32_bf16 v[76:79], v[40:43], v[52:55], v[76:79]
    ds_read_b64_tr_b16 v[28:29], v2 offset:32768
    v_exp_f32 v21, v21
    v_mfma_f32_16x16x32_bf16 v[108:111], v[44:47], v[52:55], v[108:111]
    ds_read_b64_tr_b16 v[30:31], v2 offset:36864
    v_exp_f32 v22, v22
    s_waitcnt lgkmcnt(7)
    v_mfma_f32_16x16x32_bf16 v[80:83], v[32:35], v[56:59], 0
    v_xor_b32 v2, 0x60, v2
    ds_read_b64_tr_b16 v[48:49], v2 offset:0
    v_exp_f32 v23, v23
    v_mfma_f32_16x16x32_bf16 v[112:115], v[36:39], v[56:59], 0
    ds_read_b64_tr_b16 v[50:51], v2 offset:4096
    v_add_f32 v7, v7, v20
    v_cvt_pk_bf16_f32 v20, v20, v21
    s_waitcnt lgkmcnt(6)
    v_mfma_f32_16x16x32_bf16 v[80:83], v[40:43], v[60:63], v[80:83]
    ds_read_b64_tr_b16 v[52:53], v2 offset:32768
    v_add_f32 v7, v7, v21
    v_cvt_pk_bf16_f32 v21, v22, v23
    v_mfma_f32_16x16x32_bf16 v[112:115], v[44:47], v[60:63], v[112:115]
    ds_read_b64_tr_b16 v[54:55], v2 offset:36864
    v_add_f32 v22, v22, v23
    ds_write_b64 v4, v[20:21] offset:5120
    s_waitcnt lgkmcnt(7)
    v_mfma_f32_16x16x32_bf16 v[84:87], v[32:35], v[24:27], 0
    v_xor_b32 v2, 0x20, v2
    ds_read_b64_tr_b16 v[56:57], v2 offset:0
    s_add_u32 s63, s57, 1
    v_mov_b32 v1, s63
    ds_write_b32 v3, v1
    v_add_f32 v7, v7, v22
    v_mfma_f32_16x16x32_bf16 v[116:119], v[36:39], v[24:27], 0
    ds_read_b64_tr_b16 v[58:59], v2 offset:4096
    s_waitcnt lgkmcnt(8)
    v_mfma_f32_16x16x32_bf16 v[84:87], v[40:43], v[28:31], v[84:87]
    ds_read_b64_tr_b16 v[60:61], v2 offset:32768
    v_mfma_f32_16x16x32_bf16 v[116:119], v[44:47], v[28:31], v[116:119]
    ds_read_b64_tr_b16 v[62:63], v2 offset:36864
    ds_read_b32 v1, v0
    s_waitcnt lgkmcnt(9)
    v_mfma_f32_16x16x32_bf16 v[88:91], v[32:35], v[48:51], 0
    v_xor_b32 v2, 0x10860, v2
    ds_read_b64_tr_b16 v[24:25], v2 offset:0
    v_mfma_f32_16x16x32_bf16 v[120:123], v[36:39], v[48:51], 0
    ds_read_b64_tr_b16 v[26:27], v2 offset:4096
    s_waitcnt lgkmcnt(5)
    v_mfma_f32_16x16x32_bf16 v[92:95], v[32:35], v[56:59], 0
    ds_read_b64_tr_b16 v[28:29], v2 offset:32768
    v_mfma_f32_16x16x32_bf16 v[124:127], v[36:39], v[56:59], 0
    ds_read_b64_tr_b16 v[30:31], v2 offset:36864
    s_waitcnt lgkmcnt(4)
    v_subrev_u32 v1, s63, v1
    v_cmp_lt_u32 vcc, 7, v1
    s_cbranch_vccnz L_Apc_2
L_Apc_2b:
    ds_read_b128 v[32:35], v5 offset:4096
    ds_read_b128 v[36:39], v5 offset:5120
    v_mov_b32 v1, s57
    ds_write_b32 v3, v1 offset:16
    s_cmp_lg_u32 s15, 0
    s_cbranch_scc1 L_Arf0
L_Arb0:
    v_mfma_f32_16x16x32_bf16 v[88:91], v[40:43], v[52:55], v[88:91]
    v_mfma_f32_16x16x32_bf16 v[120:123], v[44:47], v[52:55], v[120:123]
    v_xor_b32 v2, 0x20, v2
    ds_read_b64_tr_b16 v[48:49], v2 offset:0
    ds_read_b64_tr_b16 v[50:51], v2 offset:4096
    v_mfma_f32_16x16x32_bf16 v[92:95], v[40:43], v[60:63], v[92:95]
    v_mfma_f32_16x16x32_bf16 v[124:127], v[44:47], v[60:63], v[124:127]
    ds_read_b128 v[40:43], v5 offset:6144
    ds_read_b128 v[44:47], v5 offset:7168
    ds_read_b64_tr_b16 v[52:53], v2 offset:32768
    ds_read_b64_tr_b16 v[54:55], v2 offset:36864
    s_waitcnt lgkmcnt(11)
    s_waitcnt lgkmcnt(8)
    v_mfma_f32_16x16x32_bf16 v[64:67], v[32:35], v[24:27], v[64:67]
    v_xor_b32 v2, 0x60, v2
    ds_read_b64_tr_b16 v[56:57], v2 offset:0
    s_waitcnt lgkmcnt(8)
    v_mfma_f32_16x16x32_bf16 v[96:99], v[36:39], v[24:27], v[96:99]
    ds_read_b64_tr_b16 v[58:59], v2 offset:4096
    s_waitcnt lgkmcnt(5)
    v_mfma_f32_16x16x32_bf16 v[64:67], v[40:43], v[28:31], v[64:67]
    ds_read_b64_tr_b16 v[60:61], v2 offset:32768
    s_waitcnt lgkmcnt(5)
    v_mfma_f32_16x16x32_bf16 v[96:99], v[44:47], v[28:31], v[96:99]
    ds_read_b64_tr_b16 v[62:63], v2 offset:36864
    v_mfma_f32_16x16x32_bf16 v[68:71], v[32:35], v[48:51], v[68:71]
    v_xor_b32 v2, 0x20, v2
    ds_read_b64_tr_b16 v[24:25], v2 offset:0
    v_mfma_f32_16x16x32_bf16 v[100:103], v[36:39], v[48:51], v[100:103]
    ds_read_b64_tr_b16 v[26:27], v2 offset:4096
    s_waitcnt lgkmcnt(6)
    v_mfma_f32_16x16x32_bf16 v[68:71], v[40:43], v[52:55], v[68:71]
    ds_read_b64_tr_b16 v[28:29], v2 offset:32768
    v_mfma_f32_16x16x32_bf16 v[100:103], v[44:47], v[52:55], v[100:103]
    ds_read_b64_tr_b16 v[30:31], v2 offset:36864
    s_waitcnt lgkmcnt(6)
    v_mfma_f32_16x16x32_bf16 v[72:75], v[32:35], v[56:59], v[72:75]
    v_xor_b32 v2, 0x860, v2
    ds_read_b64_tr_b16 v[48:49], v2 offset:0
    v_mfma_f32_16x16x32_bf16 v[104:107], v[36:39], v[56:59], v[104:107]
    ds_read_b64_tr_b16 v[50:51], v2 offset:4096
    v_mov_b32 v16, v10
    v_mov_b32 v17, v10
    v_mov_b32 v18, v10
    v_mov_b32 v19, v10
    s_waitcnt lgkmcnt(6)
    v_mfma_f32_16x16x32_bf16 v[72:75], v[40:43], v[60:63], v[72:75]
    ds_read_b64_tr_b16 v[52:53], v2 offset:32768
    v_mfma_f32_16x16x32_bf16 v[104:107], v[44:47], v[60:63], v[104:107]
    ds_read_b64_tr_b16 v[54:55], v2 offset:36864
    v_mov_b32 v20, v11
    v_mov_b32 v21, v11
    v_mov_b32 v22, v11
    v_mov_b32 v23, v11
    s_waitcnt lgkmcnt(6)
    v_mfma_f32_16x16x32_bf16 v[76:79], v[32:35], v[24:27], v[76:79]
    v_xor_b32 v2, 0x20, v2
    ds_read_b64_tr_b16 v[56:57], v2 offset:0
    v_mfma_f32_16x16x32_bf16 v[108:111], v[36:39], v[24:27], v[108:111]
    ds_read_b64_tr_b16 v[58:59], v2 offset:4096
    s_waitcnt lgkmcnt(6)
    v_mfma_f32_16x16x32_bf16 v[76:79], v[40:43], v[28:31], v[76:79]
    ds_read_b64_tr_b16 v[60:61], v2 offset:32768
    v_mfma_f32_16x16x32_bf16 v[108:111], v[44:47], v[28:31], v[108:111]
    ds_read_b64_tr_b16 v[62:63], v2 offset:36864
    s_waitcnt lgkmcnt(6)
    v_mfma_f32_16x16x32_bf16 v[80:83], v[32:35], v[48:51], v[80:83]
    v_xor_b32 v2, 0x60, v2
    ds_read_b64_tr_b16 v[24:25], v2 offset:0
    v_mfma_f32_16x16x32_bf16 v[112:115], v[36:39], v[48:51], v[112:115]
    ds_read_b64_tr_b16 v[26:27], v2 offset:4096
    s_waitcnt lgkmcnt(6)
    v_mfma_f32_16x16x32_bf16 v[80:83], v[40:43], v[52:55], v[80:83]
    ds_read_b64_tr_b16 v[28:29], v2 offset:32768
    v_mfma_f32_16x16x32_bf16 v[112:115], v[44:47], v[52:55], v[112:115]
    ds_read_b64_tr_b16 v[30:31], v2 offset:36864
    s_waitcnt lgkmcnt(6)
    v_mfma_f32_16x16x32_bf16 v[84:87], v[32:35], v[56:59], v[84:87]
    v_xor_b32 v2, 0x20, v2
    ds_read_b64_tr_b16 v[48:49], v2 offset:0
    v_mfma_f32_16x16x32_bf16 v[116:119], v[36:39], v[56:59], v[116:119]
    ds_read_b64_tr_b16 v[50:51], v2 offset:4096
    s_waitcnt lgkmcnt(6)
    v_mfma_f32_16x16x32_bf16 v[84:87], v[40:43], v[60:63], v[84:87]
    ds_read_b64_tr_b16 v[52:53], v2 offset:32768
    v_mfma_f32_16x16x32_bf16 v[116:119], v[44:47], v[60:63], v[116:119]
    ds_read_b64_tr_b16 v[54:55], v2 offset:36864
    ds_read_b32 v1, v3 offset:32
    s_waitcnt lgkmcnt(7)
    v_mfma_f32_16x16x32_bf16 v[88:91], v[32:35], v[24:27], v[88:91]
    v_mfma_f32_16x16x32_bf16 v[120:123], v[36:39], v[24:27], v[120:123]
    s_waitcnt lgkmcnt(5)
    v_mfma_f32_16x16x32_bf16 v[88:91], v[40:43], v[28:31], v[88:91]
    v_mfma_f32_16x16x32_bf16 v[120:123], v[44:47], v[28:31], v[120:123]
    s_waitcnt lgkmcnt(0)
    v_readfirstlane_b32 s62, v1
    s_nop 0
    s_sub_u32 s62, s62, s57
    s_cmp_gt_u32 s62, 15
    s_cselect_b32 s62, 0, s62

    v_mov_b32 v1, s63
    ds_write_b32 v3, v1 offset:16
    s_cmp_lg_u32 s15, 0
    s_cbranch_scc1 L_Arf1
L_Arb1:
    s_cmp_ge_u32 s62, 2
    s_cbranch_scc0 L_Ahc_3
L_Ahc_3b:
    v_xor_b32 v12, 0x10000, v12
    ds_read_b128 v[56:59], v12 offset:0
    v_xor_b32 v13, 0x10000, v13
    ds_read_b128 v[60:63], v13 offset:0
    v_mfma_f32_16x16x32_bf16 v[92:95], v[32:35], v[48:51], v[92:95]
    v_mfma_f32_16x16x32_bf16 v[124:127], v[36:39], v[48:51], v[124:127]
    v_xor_b32 v14, 0x10000, v14
    ds_read_b128 v[24:27], v14 offset:0
    v_xor_b32 v15, 0x10000, v15
    ds_read_b128 v[28:31], v15 offset:0
    v_mfma_f32_16x16x32_bf16 v[92:95], v[40:43], v[52:55], v[92:95]
    v_mfma_f32_16x16x32_bf16 v[124:127], v[44:47], v[52:55], v[124:127]
    ds_read_b128 v[48:51], v12 offset:1024
    s_waitcnt lgkmcnt(4)
    v_mfma_f32_16x16x32_bf16 v[16:19], v[56:59], v[128:131], v[16:19]
    v_mfma_f32_16x16x32_bf16 v[20:23], v[56:59], v[192:195], v[20:23]
    ds_read_b128 v[52:55], v13 offset:1024
    s_waitcnt lgkmcnt(4)
    v_mfma_f32_16x16x32_bf16 v[16:19], v[60:63], v[132:135], v[16:19]
    v_mfma_f32_16x16x32_bf16 v[20:23], v[60:63], v[196:199], v[20:23]
    ds_read_b128 v[32:35], v14 offset:1024
    s_waitcnt lgkmcnt(4)
    v_mfma_f32_16x16x32_bf16 v[16:19], v[24:27], v[136:139], v[16:19]
    v_mfma_f32_16x16x32_bf16 v[20:23], v[24:27], v[200:203], v[20:23]
    ds_read_b128 v[36:39], v15 offset:1024
    s_waitcnt lgkmcnt(4)
    v_mfma_f32_16x16x32_bf16 v[16:19], v[28:31], v[140:143], v[16:19]
    v_mfma_f32_16x16x32_bf16 v[20:23], v[28:31], v[204:207], v[20:23]
    s_cmp_ge_u32 s62, 4
    s_cbranch_scc0 L_Ahc_4
L_Ahc_4b:
    ds_read_b128 v[40:43], v12 offset:2048
    s_waitcnt lgkmcnt(4)
    v_mfma_f32_16x16x32_bf16 v[16:19], v[48:51], v[144:147], v[16:19]
    v_mfma_f32_16x16x32_bf16 v[20:23], v[48:51], v[208:211], v[20:23]
    ds_read_b128 v[44:47], v13 offset:2048
    s_add_u32 s63, s57, 4
    ds_read_b32 v1, v0 offset:32
    s_waitcnt lgkmcnt(5)
    v_mfma_f32_16x16x32_bf16 v[16:19], v[52:55], v[148:151], v[16:19]
    v_mfma_f32_16x16x32_bf16 v[20:23], v[52:55], v[212:215], v[20:23]
    ds_read_b128 v[56:59], v14 offset:2048
    s_waitcnt lgkmcnt(5)
    v_mfma_f32_16x16x32_bf16 v[16:19], v[32:35], v[152:155], v[16:19]
    v_mfma_f32_16x16x32_bf16 v[20:23], v[32:35], v[216:219], v[20:23]
    ds_read_b128 v[60:63], v15 offset:2048
    s_waitcnt lgkmcnt(5)
    v_mfma_f32_16x16x32_bf16 v[16:19], v[36:39], v[156:159], v[16:19]
    v_mfma_f32_16x16x32_bf16 v[20:23], v[36:39], v[220:223], v[20:23]
    ds_read_b128 v[32:35], v12 offset:3072
    s_waitcnt lgkmcnt(3)
    v_subrev_u32 v1, s63, v1
    v_cmp_lt_u32 vcc, 7, v1
    s_cbranch_vccnz L_Apc_5
L_Apc_5b:
    v_mfma_f32_16x16x32_bf16 v[16:19], v[40:43], v[160:163], v[16:19]
    v_mfma_f32_16x16x32_bf16 v[20:23], v[40:43], v[224:227], v[20:23]
    ds_read_b128 v[36:39], v13 offset:3072
    v_xor_b32 v2, 0x10860, v2
    ds_read_b64_tr_b16 v[24:25], v2 offset:0
    ds_read_b64_tr_b16 v[26:27], v2 offset:4096
    v_mfma_f32_16x16x32_bf16 v[16:19], v[44:47], v[164:167], v[16:19]
    v_mfma_f32_16x16x32_bf16 v[20:23], v[44:47], v[228:231], v[20:23]
    ds_read_b128 v[40:43], v14 offset:3072
    ds_read_b64_tr_b16 v[28:29], v2 offset:32768
    ds_read_b64_tr_b16 v[30:31], v2 offset:36864
    s_waitcnt lgkmcnt(8)
    v_mfma_f32_16x16x32_bf16 v[16:19], v[56:59], v[168:171], v[16:19]
    v_mfma_f32_16x16x32_bf16 v[20:23], v[56:59], v[232:235], v[20:23]
    ds_read_b128 v[44:47], v15 offset:3072
    v_xor_b32 v2, 0x20, v2
    ds_read_b64_tr_b16 v[48:49], v2 offset:0
    ds_read_b64_tr_b16 v[50:51], v2 offset:4096
    s_waitcnt lgkmcnt(10)
    v_mfma_f32_16x16x32_bf16 v[16:19], v[60:63], v[172:175], v[16:19]
    v_mfma_f32_16x16x32_bf16 v[20:23], v[60:63], v[236:239], v[20:23]
    ds_read_b64_tr_b16 v[52:53], v2 offset:32768
    ds_read_b64_tr_b16 v[54:55], v2 offset:36864
    s_waitcnt lgkmcnt(11)
    v_mfma_f32_16x16x32_bf16 v[16:19], v[32:35], v[176:179], v[16:19]
    v_xor_b32 v2, 0x60, v2
    ds_read_b64_tr_b16 v[56:57], v2 offset:0
    ds_read_b64_tr_b16 v[58:59], v2 offset:4096
    s_waitcnt lgkmcnt(12)
    v_mfma_f32_16x16x32_bf16 v[16:19], v[36:39], v[180:183], v[16:19]
    ds_read_b64_tr_b16 v[60:61], v2 offset:32768
    ds_read_b64_tr_b16 v[62:63], v2 offset:36864
    s_waitcnt lgkmcnt(11)
    v_mfma_f32_16x16x32_bf16 v[16:19], v[40:43], v[184:187], v[16:19]
    s_waitcnt lgkmcnt(8)
    v_mfma_f32_16x16x32_bf16 v[16:19], v[44:47], v[188:191], v[16:19]
    v_mfma_f32_16x16x32_bf16 v[20:23], v[32:35], v[240:243], v[20:23]
    v_mfma_f32_16x16x32_bf16 v[20:23], v[36:39], v[244:247], v[20:23]
    v_mfma_f32_16x16x32_bf16 v[20:23], v[40:43], v[248:251], v[20:23]
    v_mfma_f32_16x16x32_bf16 v[20:23], v[44:47], v[252:255], v[20:23]
    s_nop 3
    v_exp_f32 v36, v16
    v_exp_f32 v37, v17
    v_exp_f32 v38, v18
    v_exp_f32 v39, v19
    v_cvt_pk_bf16_f32 v32, v36, v37
    v_cvt_pk_bf16_f32 v33, v38, v39
    ds_write_b64 v4, v[32:33] offset:0
    v_exp_f32 v40, v20
    v_exp_f32 v41, v21
    v_exp_f32 v42, v22
    v_exp_f32 v43, v23
    v_cvt_pk_bf16_f32 v34, v40, v41
    v_cvt_pk_bf16_f32 v35, v42, v43
    ds_write_b64 v4, v[34:35] offset:1024
    s_add_u32 s63, s57, 2
    v_mov_b32 v1, s63
    ds_write_b32 v3, v1
    v_add_f32 v36, v36, v37
    v_add_f32 v38, v38, v39
    v_max3_f32 v8, v8, v16, v17
    v_add_f32 v6, v6, v36
    v_max3_f32 v8, v8, v18, v19
    v_add_f32 v6, v6, v38
    v_add_f32 v40, v40, v41
    v_add_f32 v42, v42, v43
    v_max3_f32 v9, v9, v20, v21
    v_add_f32 v7, v7, v40
    v_max3_f32 v9, v9, v22, v23
    v_add_f32 v7, v7, v42
    ds_read_b32 v1, v0
    ds_read_b128 v[32:35], v5 offset:0
    ds_read_b128 v[36:39], v5 offset:1024
    ds_read_b128 v[40:43], v5 offset:2048
    s_waitcnt lgkmcnt(14)
    ds_read_b128 v[44:47], v5 offset:3072
    v_mov_b32 v16, v10
    v_mov_b32 v17, v10
    v_mov_b32 v18, v10
    v_mov_b32 v19, v10
    v_mov_b32 v20, v11
    v_mov_b32 v21, v11
    v_mov_b32 v22, v11
    v_mov_b32 v23, v11
    s_waitcnt lgkmcnt(4)
    v_subrev_u32 v1, s63, v1
    v_cmp_lt_u32 vcc, 7, v1
    s_cbranch_vccnz L_Apc_6
L_Apc_6b:
    s_waitcnt lgkmcnt(3)
    v_mfma_f32_16x16x32_bf16 v[64:67], v[32:35], v[24:27], v[64:67]
    s_waitcnt lgkmcnt(2)
    v_mfma_f32_16x16x32_bf16 v[96:99], v[36:39], v[24:27], v[96:99]
    s_waitcnt lgkmcnt(1)
    v_mfma_f32_16x16x32_bf16 v[64:67], v[40:43], v[28:31], v[64:67]
    s_waitcnt lgkmcnt(0)
    v_mfma_f32_16x16x32_bf16 v[96:99], v[44:47], v[28:31], v[96:99]
    v_mfma_f32_16x16x32_bf16 v[68:71], v[32:35], v[48:51], v[68:71]
    v_xor_b32 v2, 0x20, v2
    ds_read_b64_tr_b16 v[24:25], v2 offset:0
    v_mfma_f32_16x16x32_bf16 v[100:103], v[36:39], v[48:51], v[100:103]
    ds_read_b64_tr_b16 v[26:27], v2 offset:4096
    v_mfma_f32_16x16x32_bf16 v[68:71], v[40:43], v[52:55], v[68:71]
    ds_read_b64_tr_b16 v[28:29], v2 offset:32768
    v_mfma_f32_16x16x32_bf16 v[100:103], v[44:47], v[52:55], v[100:103]
    ds_read_b64_tr_b16 v[30:31], v2 offset:36864
    v_mfma_f32_16x16x32_bf16 v[72:75], v[32:35], v[56:59], v[72:75]
    v_xor_b32 v2, 0x860, v2
    ds_read_b64_tr_b16 v[48:49], v2 offset:0
    v_mfma_f32_16x16x32_bf16 v[104:107], v[36:39], v[56:59], v[104:107]
    ds_read_b64_tr_b16 v[50:51], v2 offset:4096
    v_mfma_f32_16x16x32_bf16 v[72:75], v[40:43], v[60:63], v[72:75]
    ds_read_b64_tr_b16 v[52:53], v2 offset:32768
    v_mfma_f32_16x16x32_bf16 v[104:107], v[44:47], v[60:63], v[104:107]
    ds_read_b64_tr_b16 v[54:55], v2 offset:36864
    s_waitcnt lgkmcnt(6)
    v_mfma_f32_16x16x32_bf16 v[76:79], v[32:35], v[24:27], v[76:79]
    v_xor_b32 v2, 0x20, v2
    ds_read_b64_tr_b16 v[56:57], v2 offset:0
    v_mfma_f32_16x16x32_bf16 v[108:111], v[36:39], v[24:27], v[108:111]
    ds_read_b64_tr_b16 v[58:59], v2 offset:4096
    s_waitcnt lgkmcnt(6)
    v_mfma_f32_16x16x32_bf16 v[76:79], v[40:43], v[28:31], v[76:79]
    ds_read_b64_tr_b16 v[60:61], v2 offset:32768
    v_mfma_f32_16x16x32_bf16 v[108:111], v[44:47], v[28:31], v[108:111]
    ds_read_b64_tr_b16 v[62:63], v2 offset:36864
    s_waitcnt lgkmcnt(6)
    v_mfma_f32_16x16x32_bf16 v[80:83], v[32:35], v[48:51], v[80:83]
    v_xor_b32 v2, 0x60, v2
    ds_read_b64_tr_b16 v[24:25], v2 offset:0
    v_mfma_f32_16x16x32_bf16 v[112:115], v[36:39], v[48:51], v[112:115]
    ds_read_b64_tr_b16 v[26:27], v2 offset:4096
    s_waitcnt lgkmcnt(6)
    v_mfma_f32_16x16x32_bf16 v[80:83], v[40:43], v[52:55], v[80:83]
    ds_read_b64_tr_b16 v[28:29], v2 offset:32768
    v_mfma_f32_16x16x32_bf16 v[112:115], v[44:47], v[52:55], v[112:115]
    ds_read_b64_tr_b16 v[30:31], v2 offset:36864
    s_waitcnt lgkmcnt(6)
    v_mfma_f32_16x16x32_bf16 v[84:87], v[32:35], v[56:59], v[84:87]
    v_xor_b32 v2, 0x20, v2
    ds_read_b64_tr_b16 v[48:49], v2 offset:0
    v_mfma_f32_16x16x32_bf16 v[116:119], v[36:39], v[56:59], v[116:119]
    ds_read_b64_tr_b16 v[50:51], v2 offset:4096
    s_waitcnt lgkmcnt(6)
    v_mfma_f32_16x16x32_bf16 v[84:87], v[40:43], v[60:63], v[84:87]
    ds_read_b64_tr_b16 v[52:53], v2 offset:32768
    v_mfma_f32_16x16x32_bf16 v[116:119], v[44:47], v[60:63], v[116:119]
    ds_read_b64_tr_b16 v[54:55], v2 offset:36864
    ds_read_b32 v1, v3 offset:32
    s_waitcnt lgkmcnt(7)
    v_mfma_f32_16x16x32_bf16 v[88:91], v[32:35], v[24:27], v[88:91]
    v_mfma_f32_16x16x32_bf16 v[120:123], v[36:39], v[24:27], v[120:123]
    s_waitcnt lgkmcnt(5)
    v_mfma_f32_16x16x32_bf16 v[88:91], v[40:43], v[28:31], v[88:91]
    v_mfma_f32_16x16x32_bf16 v[120:123], v[44:47], v[28:31], v[120:123]
    s_waitcnt lgkmcnt(0)
    v_readfirstlane_b32 s62, v1
    s_nop 0
    s_sub_u32 s62, s62, s57
    s_cmp_gt_u32 s62, 15
    s_cselect_b32 s62, 0, s62

    s_cmp_ge_u32 s62, 6
    s_cbranch_scc0 L_Ahc_7
L_Ahc_7b:
    v_xor_b32 v12, 0x10000, v12
    ds_read_b128 v[56:59], v12 offset:0
    v_xor_b32 v13, 0x10000, v13
    ds_read_b128 v[60:63], v13 offset:0
    v_mfma_f32_16x16x32_bf16 v[92:95], v[32:35], v[48:51], v[92:95]
    v_mfma_f32_16x16x32_bf16 v[124:127], v[36:39], v[48:51], v[124:127]
    v_xor_b32 v14, 0x10000, v14
    ds_read_b128 v[24:27], v14 offset:0
    v_xor_b32 v15, 0x10000, v15
    ds_read_b128 v[28:31], v15 offset:0
    v_mfma_f32_16x16x32_bf16 v[92:95], v[40:43], v[52:55], v[92:95]
    v_mfma_f32_16x16x32_bf16 v[124:127], v[44:47], v[52:55], v[124:127]
    ds_read_b128 v[48:51], v12 offset:1024
    s_waitcnt lgkmcnt(4)
    v_mfma_f32_16x16x32_bf16 v[16:19], v[56:59], v[128:131], v[16:19]
    v_mfma_f32_16x16x32_bf16 v[20:23], v[56:59], v[192:195], v[20:23]
    ds_read_b128 v[52:55], v13 offset:1024
    s_waitcnt lgkmcnt(4)
    v_mfma_f32_16x16x32_bf16 v[16:19], v[60:63], v[132:135], v[16:19]
    v_mfma_f32_16x16x32_bf16 v[20:23], v[60:63], v[196:199], v[20:23]
    ds_read_b128 v[32:35], v14 offset:1024
    s_waitcnt lgkmcnt(4)
    v_mfma_f32_16x16x32_bf16 v[16:19], v[24:27], v[136:139], v[16:19]
    v_mfma_f32_16x16x32_bf16 v[20:23], v[24:27], v[200:203], v[20:23]
    ds_read_b128 v[36:39], v15 offset:1024
    s_waitcnt lgkmcnt(4)
    v_mfma_f32_16x16x32_bf16 v[16:19], v[28:31], v[140:143], v[16:19]
    v_mfma_f32_16x16x32_bf16 v[20:23], v[28:31], v[204:207], v[20:23]
    s_waitcnt lgkmcnt(3)
    v_mfma_f32_16x16x32_bf16 v[16:19], v[48:51], v[144:147], v[16:19]
    v_mfma_f32_16x16x32_bf16 v[20:23], v[48:51], v[208:211], v[20:23]
    s_waitcnt lgkmcnt(2)
    v_mfma_f32_16x16x32_bf16 v[16:19], v[52:55], v[148:151], v[16:19]
    v_mfma_f32_16x16x32_bf16 v[20:23], v[52:55], v[212:215], v[20:23]
    s_waitcnt lgkmcnt(1)
    v_mfma_f32_16x16x32_bf16 v[16:19], v[32:35], v[152:155], v[16:19]
    v_mfma_f32_16x16x32_bf16 v[20:23], v[32:35], v[216:219], v[20:23]
    s_waitcnt lgkmcnt(0)
    v_mfma_f32_16x16x32_bf16 v[16:19], v[36:39], v[156:159], v[16:19]
    v_mfma_f32_16x16x32_bf16 v[20:23], v[36:39], v[220:223], v[20:23]
    v_mbcnt_lo_u32_b32 v24, -1, 0
    v_mbcnt_hi_u32_b32 v24, -1, v24
    v_and_b32 v25, 15, v24
    v_lshrrev_b32 v27, 4, v24
    v_lshlrev_b32 v26, 6, v25
    v_lshl_add_u32 v26, v27, 2, v26
    s_lshl_b32 s10, s3, 4
    s_add_u32 s10, s10, 0x22000
    v_add_u32 v26, s10, v26
    v_lshlrev_b32 v25, 4, v25
    v_lshl_add_u32 v25, v27, 19, v25
    v_bfe_u32 v28, v24, 3, 1
    v_lshl_add_u32 v27, v27, 2, v28
    v_bfe_u32 v28, v24, 2, 1
    v_lshl_add_u32 v27, v28, 1, v27
    v_and_b32 v28, 1, v24
    v_lshl_add_u32 v27, v28, 4, v27
    v_and_b32 v28, 2, v24
    v_lshlrev_b32 v28, 4, v28
    v_lshl_add_u32 v28, v27, 6, v28
    v_add_u32 v28, 0x22000, v28
    v_lshlrev_b32 v29, 4, v27
    s_lshl_b32 s10, s3, 15
    s_lshl_b32 s12, s59, 8
    s_add_u32 s10, s10, s12
    s_add_u32 s13, s10, 0x100000
    s_lshl_b32 s12, s59, 2
    s_add_u32 s12, s12, s3
    s_lshl_b32 s12, s12, 9
    s_add_u32 s12, s12, 0xa0000
    s_mov_b32 s60, 0xaaaaaaaa
    s_mov_b32 s61, 0xaaaaaaaa
    s_mov_b32 s64, 0x33333333
    s_mov_b32 s65, 0x33333333
    s_add_u32 s63, s57, 6

    ds_read_b32 v1, v0 offset:32
    s_waitcnt lgkmcnt(0)
    v_subrev_u32 v1, s63, v1
    v_cmp_lt_u32 vcc, 7, v1
    s_cbranch_vccnz L_Apc_8
L_Apc_8b:
    v_xor_b32 v2, 0x10860, v2
    ds_read_b64_tr_b16 v[128:129], v2 offset:0
    ds_read_b64_tr_b16 v[130:131], v2 offset:4096
    ds_read_b64_tr_b16 v[132:133], v2 offset:32768
    ds_read_b64_tr_b16 v[134:135], v2 offset:36864
    v_xor_b32 v2, 0x20, v2
    ds_read_b64_tr_b16 v[136:137], v2 offset:0
    ds_read_b64_tr_b16 v[138:139], v2 offset:4096
    ds_read_b64_tr_b16 v[140:141], v2 offset:32768
    ds_read_b64_tr_b16 v[142:143], v2 offset:36864
    v_xor_b32 v2, 0x60, v2
    ds_read_b64_tr_b16 v[144:145], v2 offset:0
    ds_read_b64_tr_b16 v[146:147], v2 offset:4096
    ds_read_b64_tr_b16 v[148:149], v2 offset:32768
    ds_read_b64_tr_b16 v[150:151], v2 offset:36864
    v_xor_b32 v2, 0x20, v2
    ds_read_b64_tr_b16 v[152:153], v2 offset:0
    ds_read_b64_tr_b16 v[154:155], v2 offset:4096
    ds_read_b64_tr_b16 v[156:157], v2 offset:32768
    s_waitcnt lgkmcnt(14)
    ds_read_b64_tr_b16 v[158:159], v2 offset:36864
    v_xor_b32 v2, 0x860, v2
    s_waitcnt lgkmcnt(0)
    s_barrier
    ds_read_b128 v[32:35], v12 offset:2048
    ds_read_b128 v[36:39], v13 offset:2048
    ds_read_b128 v[40:43], v14 offset:2048
    ds_read_b128 v[44:47], v15 offset:2048
    ds_read_b128 v[48:51], v12 offset:3072
    ds_read_b128 v[52:55], v13 offset:3072
    ds_read_b128 v[56:59], v14 offset:3072
    ds_read_b128 v[60:63], v15 offset:3072
    s_waitcnt lgkmcnt(7)
    v_mfma_f32_16x16x32_bf16 v[16:19], v[32:35], v[160:163], v[16:19]
    s_waitcnt lgkmcnt(6)
    v_mfma_f32_16x16x32_bf16 v[16:19], v[36:39], v[164:167], v[16:19]
    s_waitcnt lgkmcnt(5)
    v_mfma_f32_16x16x32_bf16 v[16:19], v[40:43], v[168:171], v[16:19]
    s_waitcnt lgkmcnt(4)
    v_mfma_f32_16x16x32_bf16 v[16:19], v[44:47], v[172:175], v[16:19]
    ds_read_b64_tr_b16 v[192:193], v2 offset:0
    ds_read_b64_tr_b16 v[194:195], v2 offset:4096
    s_waitcnt lgkmcnt(5)
    v_mfma_f32_16x16x32_bf16 v[16:19], v[48:51], v[176:179], v[16:19]
    s_waitcnt lgkmcnt(4)
    v_mfma_f32_16x16x32_bf16 v[16:19], v[52:55], v[180:183], v[16:19]
    ds_read_b64_tr_b16 v[196:197], v2 offset:32768
    ds_read_b64_tr_b16 v[198:199], v2 offset:36864
    s_waitcnt lgkmcnt(5)
    v_mfma_f32_16x16x32_bf16 v[16:19], v[56:59], v[184:187], v[16:19]
    s_waitcnt lgkmcnt(4)
    v_mfma_f32_16x16x32_bf16 v[16:19], v[60:63], v[188:191], v[16:19]
    v_xor_b32 v2, 0x20, v2
    ds_read_b64_tr_b16 v[200:201], v2 offset:0
    ds_read_b64_tr_b16 v[202:203], v2 offset:4096
    v_mfma_f32_16x16x32_bf16 v[20:23], v[32:35], v[224:227], v[20:23]
    v_mfma_f32_16x16x32_bf16 v[20:23], v[36:39], v[228:231], v[20:23]
    ds_read_b64_tr_b16 v[204:205], v2 offset:32768
    ds_read_b64_tr_b16 v[206:207], v2 offset:36864
    v_mfma_f32_16x16x32_bf16 v[20:23], v[40:43], v[232:235], v[20:23]
    v_mfma_f32_16x16x32_bf16 v[20:23], v[44:47], v[236:239], v[20:23]
    v_exp_f32 v188, v16
    v_exp_f32 v189, v17
    v_mfma_f32_16x16x32_bf16 v[20:23], v[48:51], v[240:243], v[20:23]
    v_exp_f32 v190, v18
    v_exp_f32 v191, v19
    v_mfma_f32_16x16x32_bf16 v[20:23], v[52:55], v[244:247], v[20:23]
    v_cvt_pk_bf16_f32 v182, v188, v189
    v_cvt_pk_bf16_f32 v183, v190, v191
    ds_write_b64 v4, v[182:183] offset:4096
    v_mfma_f32_16x16x32_bf16 v[20:23], v[56:59], v[248:251], v[20:23]
    v_mfma_f32_16x16x32_bf16 v[20:23], v[60:63], v[252:255], v[20:23]
    s_waitcnt lgkmcnt(0)
    s_barrier
    ds_read_b128 v[32:35], v5 offset:4096
    ds_read_b128 v[40:43], v5 offset:6144
    s_nop 3
    v_exp_f32 v232, v20
    v_exp_f32 v233, v21
    v_exp_f32 v234, v22
    v_exp_f32 v235, v23
    v_cvt_pk_bf16_f32 v236, v232, v233
    v_cvt_pk_bf16_f32 v237, v234, v235
    ds_write_b64 v4, v[236:237] offset:5120
    s_waitcnt lgkmcnt(2)
    v_mfma_f32_16x16x32_bf16 v[64:67], v[32:35], v[128:131], v[64:67]
    s_waitcnt lgkmcnt(1)
    v_mfma_f32_16x16x32_bf16 v[64:67], v[40:43], v[132:135], v[64:67]
    v_xor_b32 v2, 0x60, v2
    ds_read_b64_tr_b16 v[208:209], v2 offset:0
    ds_read_b64_tr_b16 v[210:211], v2 offset:4096
    v_add_f32 v188, v188, v189
    v_add_f32 v190, v190, v191
    v_add_f32 v6, v6, v188
    v_add_f32 v6, v6, v190
    v_mfma_f32_16x16x32_bf16 v[68:71], v[32:35], v[136:139], v[68:71]
    v_mfma_f32_16x16x32_bf16 v[68:71], v[40:43], v[140:143], v[68:71]
    ds_read_b64_tr_b16 v[212:213], v2 offset:32768
    ds_read_b64_tr_b16 v[214:215], v2 offset:36864
    v_add_f32 v232, v232, v233
    v_add_f32 v234, v234, v235
    v_add_f32 v7, v7, v232
    v_add_f32 v7, v7, v234
    ds_write2st64_b32 v26, v6, v7 offset0:0 offset1:4
    v_mfma_f32_16x16x32_bf16 v[72:75], v[32:35], v[144:147], v[72:75]
    v_mfma_f32_16x16x32_bf16 v[72:75], v[40:43], v[148:151], v[72:75]
    v_xor_b32 v2, 0x20, v2
    ds_read_b64_tr_b16 v[216:217], v2 offset:0
    ds_read_b64_tr_b16 v[218:219], v2 offset:4096
    v_mfma_f32_16x16x32_bf16 v[76:79], v[32:35], v[152:155], v[76:79]
    v_mfma_f32_16x16x32_bf16 v[76:79], v[40:43], v[156:159], v[76:79]
    ds_read_b64_tr_b16 v[220:221], v2 offset:32768
    ds_read_b64_tr_b16 v[222:223], v2 offset:36864
    v_mfma_f32_16x16x32_bf16 v[80:83], v[32:35], v[192:195], v[80:83]
    v_mfma_f32_16x16x32_bf16 v[80:83], v[40:43], v[196:199], v[80:83]
    s_waitcnt lgkmcnt(4)
    s_barrier
    ds_read_b128 v[36:39], v5 offset:5120
    ds_read_b128 v[44:47], v5 offset:7168
    v_mfma_f32_16x16x32_bf16 v[84:87], v[32:35], v[200:203], v[84:87]
    v_mfma_f32_16x16x32_bf16 v[84:87], v[40:43], v[204:207], v[84:87]
    ds_read_b128 v[224:227], v28
    ds_read_b128 v[228:231], v28 offset:16
    v_mfma_f32_16x16x32_bf16 v[88:91], v[32:35], v[208:211], v[88:91]
    v_mfma_f32_16x16x32_bf16 v[88:91], v[40:43], v[212:215], v[88:91]
    v_max3_f32 v8, v8, v16, v17
    v_max3_f32 v8, v8, v18, v19
    s_waitcnt lgkmcnt(6)
    v_mfma_f32_16x16x32_bf16 v[92:95], v[32:35], v[216:219], v[92:95]
    s_waitcnt lgkmcnt(4)
    v_mfma_f32_16x16x32_bf16 v[92:95], v[40:43], v[220:223], v[92:95]
    v_max3_f32 v9, v9, v20, v21
    v_max3_f32 v9, v9, v22, v23
    s_waitcnt lgkmcnt(3)
    v_mfma_f32_16x16x32_bf16 v[96:99], v[36:39], v[128:131], v[96:99]
    s_waitcnt lgkmcnt(2)
    v_mfma_f32_16x16x32_bf16 v[96:99], v[44:47], v[132:135], v[96:99]
    s_waitcnt lgkmcnt(0)
    v_add_f32 v224, v224, v225
    v_add_f32 v226, v226, v227
    v_add_f32 v228, v228, v229
    v_add_f32 v230, v230, v231

    v_mfma_f32_16x16x32_bf16 v[100:103], v[36:39], v[136:139], v[100:103]
    v_mfma_f32_16x16x32_bf16 v[100:103], v[44:47], v[140:143], v[100:103]
    v_add_f32 v224, v224, v226
    v_add_f32 v228, v228, v230
    v_add_f32 v185, v224, v228
    v_mov_b32 v187, s58

    v_mfma_f32_16x16x32_bf16 v[104:107], v[36:39], v[144:147], v[104:107]
    v_mfma_f32_16x16x32_bf16 v[104:107], v[44:47], v[148:151], v[104:107]
    v_cvt_pk_bf16_f32 v48, v64, v68
    v_cvt_pk_bf16_f32 v49, v72, v76
    v_cvt_pk_bf16_f32 v50, v80, v84
    v_cvt_pk_bf16_f32 v51, v88, v92
    v_add_f32_dpp v185, v185, v185 quad_perm:[2,3,0,1] row_mask:0xf bank_mask:0xf
    v_mfma_f32_16x16x32_bf16 v[108:111], v[36:39], v[152:155], v[108:111]
    v_mfma_f32_16x16x32_bf16 v[108:111], v[44:47], v[156:159], v[108:111]
    s_add_u32 s11, s13, 0x0
    buffer_store_dwordx4 v[48:51], v25, s[44:47], s11 offen sc1
    v_cvt_pk_bf16_f32 v52, v65, v69
    v_cvt_pk_bf16_f32 v53, v73, v77
    v_cvt_pk_bf16_f32 v54, v81, v85
    v_cvt_pk_bf16_f32 v55, v89, v93
    v_mfma_f32_16x16x32_bf16 v[112:115], v[36:39], v[192:195], v[112:115]
    v_mfma_f32_16x16x32_bf16 v[112:115], v[44:47], v[196:199], v[112:115]
    s_add_u32 s11, s13, 0x20000
    buffer_store_dwordx4 v[52:55], v25, s[44:47], s11 offen sc1
    v_cvt_pk_bf16_f32 v56, v66, v70
    v_cvt_pk_bf16_f32 v57, v74, v78
    v_cvt_pk_bf16_f32 v58, v82, v86
    v_cvt_pk_bf16_f32 v59, v90, v94
    v_mfma_f32_16x16x32_bf16 v[116:119], v[36:39], v[200:203], v[116:119]
    v_mfma_f32_16x16x32_bf16 v[116:119], v[44:47], v[204:207], v[116:119]
    s_add_u32 s11, s13, 0x40000
    buffer_store_dwordx4 v[56:59], v25, s[44:47], s11 offen sc1
    v_cvt_pk_bf16_f32 v60, v67, v71
    v_cvt_pk_bf16_f32 v61, v75, v79
    v_cvt_pk_bf16_f32 v62, v83, v87
    v_cvt_pk_bf16_f32 v63, v91, v95
    v_mfma_f32_16x16x32_bf16 v[120:123], v[36:39], v[208:211], v[120:123]
    v_mfma_f32_16x16x32_bf16 v[120:123], v[44:47], v[212:215], v[120:123]
    s_add_u32 s11, s13, 0x60000
    buffer_store_dwordx4 v[60:63], v25, s[44:47], s11 offen sc1
    v_add3_u32 v168, v48, v49, v50
    v_add_u32 v168, v168, v51
    v_add3_u32 v169, v52, v53, v54
    v_add_u32 v169, v169, v55
    v_mfma_f32_16x16x32_bf16 v[124:127], v[36:39], v[216:219], v[124:127]
    v_mfma_f32_16x16x32_bf16 v[124:127], v[44:47], v[220:223], v[124:127]
    v_add3_u32 v170, v56, v57, v58
    v_add_u32 v170, v170, v59
    v_add3_u32 v171, v60, v61, v62
    v_add_u32 v171, v171, v63
    v_add_u32_dpp v176, v168, v168 row_ror:8 row_mask:0xf bank_mask:0x3
    s_nop 1
    v_add_u32_dpp v176, v169, v169 row_ror:8 row_mask:0xf bank_mask:0xc
    v_add_u32_dpp v177, v170, v170 row_ror:8 row_mask:0xf bank_mask:0x3
    s_nop 1
    v_add_u32_dpp v177, v171, v171 row_ror:8 row_mask:0xf bank_mask:0xc
    v_subrev_u32 v186, 0x2f800000, v185
    v_cmp_le_u32 vcc, 0x24000000, v186

    v_cvt_pk_bf16_f32 v16, v96, v100
    v_cvt_pk_bf16_f32 v17, v104, v108
    v_cvt_pk_bf16_f32 v18, v112, v116
    v_cvt_pk_bf16_f32 v19, v120, v124
    v_add_u32_dpp v180, v176, v176 row_half_mirror row_mask:0xf bank_mask:0x5
    s_nop 1
    v_add_u32_dpp v180, v177, v177 row_half_mirror row_mask:0xf bank_mask:0xa
    s_nop 1
    v_add_u32_dpp v180, v180, v180 quad_perm:[1,0,3,2] row_mask:0xf bank_mask:0xf
    v_cvt_pk_bf16_f32 v20, v97, v101
    v_cvt_pk_bf16_f32 v21, v105, v109
    v_cvt_pk_bf16_f32 v22, v113, v117
    v_cvt_pk_bf16_f32 v23, v121, v125
    v_add3_u32 v172, v16, v17, v18
    v_add_u32 v172, v172, v19
    v_cvt_pk_bf16_f32 v160, v98, v102
    v_cvt_pk_bf16_f32 v161, v106, v110
    v_cvt_pk_bf16_f32 v162, v114, v118
    v_cvt_pk_bf16_f32 v163, v122, v126
    v_add3_u32 v173, v20, v21, v22
    v_add_u32 v173, v173, v23
    v_cvt_pk_bf16_f32 v164, v99, v103
    v_cvt_pk_bf16_f32 v165, v107, v111
    v_cvt_pk_bf16_f32 v166, v115, v119
    v_cvt_pk_bf16_f32 v167, v123, v127
    v_add3_u32 v174, v160, v161, v162
    v_add_u32 v174, v174, v163
    v_add_u32_dpp v178, v172, v172 row_ror:8 row_mask:0xf bank_mask:0x3
    s_nop 1
    v_add_u32_dpp v178, v173, v173 row_ror:8 row_mask:0xf bank_mask:0xc
    v_add3_u32 v175, v164, v165, v166
    v_add_u32 v175, v175, v167
    s_or_b32 s14, vcc_lo, vcc_hi
    s_or_b32 s11, s14, s15
    s_cbranch_scc1 L_Aslow
    v_mov_b32 v184, 0
L_Aok:

    v_add_u32_dpp v179, v174, v174 row_ror:8 row_mask:0xf bank_mask:0x3
    s_nop 1
    v_add_u32_dpp v179, v175, v175 row_ror:8 row_mask:0xf bank_mask:0xc
    v_sub_u32 v186, v187, v184
    v_add_u32_dpp v181, v178, v178 row_half_mirror row_mask:0xf bank_mask:0x5
    s_nop 1
    v_add_u32_dpp v181, v179, v179 row_half_mirror row_mask:0xf bank_mask:0xa
    s_nop 1
    v_add_u32_dpp v181, v181, v181 quad_perm:[1,0,3,2] row_mask:0xf bank_mask:0xf
    v_sub_u32 v186, v186, v185
    v_cndmask_b32 v180, v180, v181, s[60:61]
    s_nop 1
    v_add_u32_dpp v180, v180, v180 quad_perm:[2,3,0,1] row_mask:0xf bank_mask:0xf
    v_sub_u32 v186, v186, v180
    s_mov_b64 exec, s[64:65]
    buffer_store_dwordx4 v[184:187], v29, s[44:47], s12 offen sc1
    s_mov_b64 exec, -1

    s_add_u32 s11, s13, 0x201000
    buffer_store_dwordx4 v[16:19], v25, s[44:47], s11 offen sc1
    s_add_u32 s11, s13, 0x221000
    buffer_store_dwordx4 v[20:23], v25, s[44:47], s11 offen sc1
    s_add_u32 s11, s13, 0x241000
    buffer_store_dwordx4 v[160:163], v25, s[44:47], s11 offen sc1
    s_add_u32 s11, s13, 0x261000
    buffer_store_dwordx4 v[164:167], v25, s[44:47], s11 offen sc1
    s_cmp_lg_u32 s3, 0
    s_cbranch_scc1 L_end

    s_mov_b32 s48, s38
    s_mov_b32 s49, s39
    s_mov_b32 s50, 0x8b000
    s_mov_b32 s51, 0x20000
    s_mov_b32 s40, s16
    s_mov_b32 s41, s17
    s_mov_b32 s42, 0x400
    s_mov_b32 s43, 0x20000
    v_mov_b32 v40, v24
    s_and_b32 s10, s2, 7
    s_lshl_b32 s10, s10, 6
    s_lshr_b32 s11, s2, 3
    s_lshl_b32 s11, s11, 2
    s_add_u32 s10, s10, s11
    s_lshl_b32 s11, s10, 2
    s_lshl_b32 s12, s10, 1
    v_lshlrev_b32 v41, 11, v40
    v_and_b32 v42, 3, v40
    v_lshlrev_b32 v43, 1, v42
    buffer_load_ushort v60, v43, s[40:43], s12 offen
    v_and_b32 v44, 1, v40
    v_cmp_eq_u32 s[60:61], 1, v44
    v_and_b32 v44, 2, v40
    v_cmp_eq_u32 s[62:63], 2, v44

    s_add_u32 s13, s11, 0x60000
    s_add_u32 s14, s11, 0x80000
    s_mov_b32 s8, 0
    s_mov_b64 s[64:65], -1
    s_mov_b64 s[66:67], -1
L_gf:
    s_sleep 0
    s_mov_b64 exec, s[64:65]
    s_cbranch_execz L_gf_a
    buffer_load_dwordx4 v[48:51], v41, s[48:51], s13 offen sc1
L_gf_a:
    s_mov_b64 exec, s[66:67]
    s_cbranch_execz L_gf_b
    buffer_load_dwordx4 v[52:55], v41, s[48:51], s14 offen sc1
L_gf_b:
    s_mov_b64 exec, -1
    s_add_u32 s8, s8, 1
    s_waitcnt vmcnt(0)
    v_max3_u32 v56, v48, v49, v50
    v_max3_u32 v57, v52, v53, v54
    v_max_u32 v56, v56, v51
    v_max_u32 v57, v57, v55
    v_cmp_eq_u32 s[64:65], -1, v56
    v_cmp_eq_u32 s[66:67], -1, v57
    s_cmp_gt_u32 s8, 60000
    s_cbranch_scc1 L_gf_x
    s_or_b64 s[68:69], s[64:65], s[66:67]
    s_cbranch_scc1 L_gf
L_gf_x:
    v_add_f32 v48, v48, v52
    v_add_f32 v49, v49, v53
    v_add_f32 v50, v50, v54
    v_add_f32 v51, v51, v55
    v_cndmask_b32 v52, v48, v49, s[60:61]
    v_cndmask_b32 v53, v49, v48, s[60:61]
    v_cndmask_b32 v54, v50, v51, s[60:61]
    v_cndmask_b32 v55, v51, v50, s[60:61]
    v_add_f32_dpp v52, v53, v52 quad_perm:[1,0,3,2] row_mask:0xf bank_mask:0xf
    s_nop 0
    v_add_f32_dpp v54, v55, v54 quad_perm:[1,0,3,2] row_mask:0xf bank_mask:0xf
    v_cndmask_b32 v61, v52, v54, s[62:63]
    v_cndmask_b32 v53, v54, v52, s[62:63]
    s_nop 1
    v_add_f32_dpp v61, v53, v61 quad_perm:[2,3,0,1] row_mask:0xf bank_mask:0xf
    s_nop 1
    v_add_f32_dpp v61, v61, v61 row_ror:4 row_mask:0xf bank_mask:0xf
    s_nop 1
    v_add_f32_dpp v61, v61, v61 row_ror:8 row_mask:0xf bank_mask:0xf

    v_mov_b32 v53, v61
    s_nop 1
    v_permlane16_swap_b32 v61, v53
    v_add_f32 v61, v61, v53
    v_mov_b32 v53, v61
    s_nop 1
    v_permlane32_swap_b32 v61, v53
    v_add_f32 v61, v61, v53
    v_cvt_pk_bf16_f32 v61, v61, v61
    v_lshlrev_b32 v61, 16, v61
    v_mul_f32 v53, 0xbfb8aa3b, v61
    v_exp_f32 v53, v53
    s_nop 0
    v_add_f32 v53, 1.0, v53
    v_rcp_f32 v53, v53
    s_nop 0
    v_mul_f32 v61, v61, v53
    v_cvt_pk_bf16_f32 v61, v61, v61
    v_lshlrev_b32 v61, 16, v61
    v_lshlrev_b32 v60, 16, v60
    s_mov_b32 s40, s34
    s_mov_b32 s41, s35
    s_mov_b32 s42, 0x400
    s_mov_b32 s43, 0x20000
    s_add_u32 s13, s11, 0x20000
    s_add_u32 s14, s11, 0x40000
    s_mov_b32 s8, 0
    s_mov_b32 s64, 0x00010001
    s_mov_b32 s65, 0x00010001
    s_mov_b64 exec, s[64:65]
L_gr:
    buffer_load_dword v48, v41, s[44:47], s13 offen sc1
    buffer_load_dword v52, v41, s[44:47], s14 offen sc1
    s_add_u32 s8, s8, 1
    s_waitcnt vmcnt(0)
    v_cmp_ne_u32 s[66:67], -1, v48
    v_cmp_ne_u32 s[68:69], -1, v52
    s_bcnt1_i32_b64 s66, s[66:67]
    s_bcnt1_i32_b64 s68, s[68:69]
    s_add_u32 s66, s66, s68
    s_cmp_gt_u32 s8, 60000
    s_cbranch_scc1 L_gr_x
    s_cmp_lt_u32 s66, 4
    s_cbranch_scc1 L_gr
L_gr_x:

    s_mov_b64 s[64:65], -1
    s_mov_b64 s[66:67], -1
L_gs:
    s_sleep 0
    s_mov_b64 exec, s[64:65]
    s_cbranch_execz L_gs_a
    buffer_load_dwordx4 v[48:51], v41, s[44:47], s13 offen sc1
L_gs_a:
    s_mov_b64 exec, s[66:67]
    s_cbranch_execz L_gs_b
    buffer_load_dwordx4 v[52:55], v41, s[44:47], s14 offen sc1
L_gs_b:
    s_mov_b64 exec, -1
    s_add_u32 s8, s8, 1
    s_waitcnt vmcnt(0)
    v_max3_u32 v56, v48, v49, v50
    v_max3_u32 v57, v52, v53, v54
    v_max_u32 v56, v56, v51
    v_max_u32 v57, v57, v55
    v_cmp_eq_u32 s[64:65], -1, v56
    v_cmp_eq_u32 s[66:67], -1, v57
    s_cmp_gt_u32 s8, 60000
    s_cbranch_scc1 L_gs_x
    s_or_b64 s[68:69], s[64:65], s[66:67]
    s_cbranch_scc1 L_gs
L_gs_x:
    v_add_f32 v48, v48, v52
    v_add_f32 v49, v49, v53
    v_add_f32 v50, v50, v54
    v_add_f32 v51, v51, v55
    v_cndmask_b32 v52, v48, v49, s[60:61]
    v_cndmask_b32 v53, v49, v48, s[60:61]
    v_cndmask_b32 v54, v50, v51, s[60:61]
    v_cndmask_b32 v55, v51, v50, s[60:61]
    v_add_f32_dpp v52, v53, v52 quad_perm:[1,0,3,2] row_mask:0xf bank_mask:0xf
    s_nop 0
    v_add_f32_dpp v54, v55, v54 quad_perm:[1,0,3,2] row_mask:0xf bank_mask:0xf
    v_cndmask_b32 v62, v52, v54, s[62:63]
    v_cndmask_b32 v53, v54, v52, s[62:63]
    s_nop 1
    v_add_f32_dpp v62, v53, v62 quad_perm:[2,3,0,1] row_mask:0xf bank_mask:0xf
    s_nop 1
    v_add_f32_dpp v62, v62, v62 row_ror:4 row_mask:0xf bank_mask:0xf
    s_nop 1
    v_add_f32_dpp v62, v62, v62 row_ror:8 row_mask:0xf bank_mask:0xf

    v_mov_b32 v53, v62
    s_nop 1
    v_permlane16_swap_b32 v62, v53
    v_add_f32 v62, v62, v53
    v_mov_b32 v53, v62
    s_nop 1
    v_permlane32_swap_b32 v62, v53
    v_add_f32 v62, v62, v53
    v_cvt_pk_bf16_f32 v62, v62, v62
    v_lshlrev_b32 v62, 16, v62
    v_mul_f32 v62, v62, v61
    v_cvt_pk_bf16_f32 v62, v62, v62
    v_lshlrev_b32 v62, 16, v62
    v_add_f32 v62, v62, v60
    v_cvt_pk_bf16_f32 v62, v62, v62
    s_mov_b64 exec, 15
    buffer_store_short v62, v43, s[40:43], s12 offen

    s_endpgm
L_As:
    s_setprio 3
    s_sub_u32 s3, s3, 4
    s_cmp_lg_u32 s3, 1
    s_cbranch_scc1 L_Apt
    s_load_dword s60, s[38:39], 0x1f000
    s_load_dword s60, s[26:27], 0x0
    s_load_dword s60, s[30:31], 0x0
    s_load_dword s60, s[32:33], 0x0
    s_load_dword s60, s[24:25], 0x0
    s_load_dword s60, s[34:35], 0x0
    s_mov_b32 s61, 0x300000
    s_load_dword s60, s[38:39], s61
    s_load_dword s60, s[26:27], s61
    s_load_dword s60, s[24:25], s61
    s_mov_b32 s62, 0x502000
    s_load_dword s60, s[38:39], s62
L_Apt:
    s_lshl_b32 s9, s3, 14
    s_add_u32 s64, s8, s9
    s_lshl_b32 s10, s3, 8
    s_or_b32 s66, s64, s10
    s_lshl_b32 s10, s3, 10
    s_or_b32 s69, s9, s10
    s_add_u32 s64, s64, 0x20000
    v_lshl_add_u32 v100, v1, 4, s9
    v_add_u32 v101, 0x10000, v100
    v_mov_b32 v2, 0
    s_mov_b32 s8, 0
L_Agn:
    s_sleep 8
    global_load_dword v5, v2, s[36:37] sc1
    s_add_u32 s8, s8, 1
    s_waitcnt vmcnt(0)
    v_readfirstlane_b32 s4, v5
    s_cmp_gt_u32 s8, 60000
    s_cbranch_scc1 L_Agn_x
    s_cmp_eq_u32 s4, 0
    s_cbranch_scc1 L_Agn
L_Agn_x:

    s_xor_b32 m0, s69, 0x11000
    s_xor_b32 s10, s66, 0x11000
    buffer_load_dwordx4 v3, s[40:43], s10 offen nt lds
    s_xor_b32 m0, s69, 0x11400
    s_xor_b32 s10, s66, 0x11100
    buffer_load_dwordx4 v3, s[40:43], s10 offen nt lds
    s_xor_b32 m0, s69, 0x11800
    s_xor_b32 s10, s66, 0x11200
    buffer_load_dwordx4 v3, s[40:43], s10 offen nt lds
    s_xor_b32 m0, s69, 0x11c00
    s_xor_b32 s10, s66, 0x11300
    buffer_load_dwordx4 v3, s[40:43], s10 offen nt lds
    s_waitcnt vmcnt(3)
    s_xor_b32 m0, s69, 0x12000
    s_xor_b32 s10, s66, 0x12000
    buffer_load_dwordx4 v0, s[40:43], s10 offen nt lds
    s_waitcnt vmcnt(3)
    s_xor_b32 m0, s69, 0x12400
    s_xor_b32 s10, s66, 0x12100
    buffer_load_dwordx4 v0, s[40:43], s10 offen nt lds
    s_waitcnt vmcnt(3)
    s_xor_b32 m0, s69, 0x12800
    s_xor_b32 s10, s66, 0x12200
    buffer_load_dwordx4 v0, s[40:43], s10 offen nt lds
    s_waitcnt vmcnt(3)
    s_xor_b32 m0, s69, 0x12c00
    s_xor_b32 s10, s66, 0x12300
    buffer_load_dwordx4 v0, s[40:43], s10 offen nt lds
    s_waitcnt vmcnt(3)
    s_xor_b32 m0, s69, 0x13000
    s_xor_b32 s10, s66, 0x13000
    buffer_load_dwordx4 v0, s[40:43], s10 offen nt lds
    s_waitcnt vmcnt(3)
    s_xor_b32 m0, s69, 0x13400
    s_xor_b32 s10, s66, 0x13100
    buffer_load_dwordx4 v0, s[40:43], s10 offen nt lds
    s_waitcnt vmcnt(3)
    s_xor_b32 m0, s69, 0x13800
    s_xor_b32 s10, s66, 0x13200
    buffer_load_dwordx4 v0, s[40:43], s10 offen nt lds
    s_waitcnt vmcnt(3)
    s_xor_b32 m0, s69, 0x13c00
    s_xor_b32 s10, s66, 0x13300
    buffer_load_dwordx4 v0, s[40:43], s10 offen nt lds
    v_lshlrev_b32 v2, 5, v1
    v_lshlrev_b32 v98, 4, v1
    v_lshlrev_b32 v97, 7, v1
    s_lshl_b32 s9, s3, 13
    s_add_u32 s65, s9, 4096
    s_lshl_b32 s11, s3, 10
    s_add_u32 s11, s11, 0x8000
    s_lshr_b32 s12, s3, 1
    s_lshl_b32 s12, s12, 14
    s_and_b32 s13, s3, 1
    s_lshl_b32 s13, s13, 7
    s_add_u32 s12, s12, s13
    s_add_u32 s12, s12, 0x20000
    v_and_b32 v6, 7, v1
    v_lshlrev_b32 v6, 4, v6
    v_lshl_add_u32 v6, v1, 8, v6
    v_add_u32 v6, s12, v6
    s_lshl_b32 s4, s4, 5
    v_mov_b32 v72, 0
    v_mov_b32 v73, 0
    s_lshl_b32 s68, s3, 10
    s_add_u32 s68, s68, 0x10000
    s_mov_b32 s12, 0xff
    s_mov_b32 s13, 0

L_Agt:
    s_sleep 1
    s_mov_b64 exec, s[12:13]
    buffer_load_dwordx2 v[72:73], v97, s[44:47], s68 offen sc1
    s_add_u32 s8, s8, 1
    s_waitcnt vmcnt(0)
L_Agt_c:
    v_cmp_ne_u32 s[12:13], v73, v5
    s_cmp_gt_u32 s8, 60000
    s_cbranch_scc1 L_Agt_x
    s_cmp_lg_u32 s12, 0
    s_cbranch_scc1 L_Agt
L_Agt_x:
    s_mov_b32 exec_lo, -1
    buffer_load_dwordx2 v[72:73], v2, s[44:47], s11 offen sc1
    s_mov_b64 exec, -1

    buffer_load_dwordx4 v[8:11], v98, s[44:47], s9 offen offset:0 sc1
    buffer_load_dwordx4 v[12:15], v98, s[44:47], s9 offen offset:1024 sc1
    buffer_load_dwordx4 v[16:19], v98, s[44:47], s9 offen offset:2048 sc1
    buffer_load_dwordx4 v[20:23], v98, s[44:47], s9 offen offset:3072 sc1
    buffer_load_dwordx4 v[24:27], v98, s[44:47], s65 offen offset:0 sc1
    buffer_load_dwordx4 v[28:31], v98, s[44:47], s65 offen offset:1024 sc1
    buffer_load_dwordx4 v[32:35], v98, s[44:47], s65 offen offset:2048 sc1
    buffer_load_dwordx4 v[36:39], v98, s[44:47], s65 offen offset:3072 sc1
    s_barrier
    s_add_u32 s10, s64, 0x0
    buffer_load_dwordx4 v[128:131], v3, s[40:43], s10 offen nt
    s_add_u32 s10, s64, 0x100
    buffer_load_dwordx4 v[132:135], v3, s[40:43], s10 offen nt
    s_add_u32 s10, s64, 0x1000
    buffer_load_dwordx4 v[136:139], v3, s[40:43], s10 offen nt
    s_add_u32 s10, s64, 0x1100
    buffer_load_dwordx4 v[140:143], v3, s[40:43], s10 offen nt
    s_add_u32 s10, s64, 0x2000
    buffer_load_dwordx4 v[144:147], v0, s[40:43], s10 offen nt
    s_add_u32 s10, s64, 0x2100
    buffer_load_dwordx4 v[148:151], v0, s[40:43], s10 offen nt
    v_xor_b32 v40, 0, v6
    v_xor_b32 v41, 16, v6
    v_xor_b32 v42, 32, v6
    v_xor_b32 v43, 48, v6
    v_xor_b32 v44, 64, v6
    v_xor_b32 v45, 80, v6
    v_xor_b32 v46, 96, v6
    v_xor_b32 v47, 112, v6
    s_waitcnt vmcnt(13)
    ds_write_b128 v40, v[8:11]
    v_add3_u32 v80, v8, v9, v10
    v_add_u32 v80, v80, v11
    s_waitcnt vmcnt(12)
    ds_write_b128 v41, v[12:15]
    v_add3_u32 v81, v12, v13, v14
    v_add_u32 v81, v81, v15
    s_waitcnt vmcnt(11)
    ds_write_b128 v42, v[16:19]
    v_add3_u32 v82, v16, v17, v18
    v_add_u32 v82, v82, v19
    s_waitcnt vmcnt(10)
    ds_write_b128 v43, v[20:23]
    v_add3_u32 v83, v20, v21, v22
    v_add_u32 v83, v83, v23
    s_waitcnt vmcnt(9)
    ds_write_b128 v44, v[24:27]
    v_add3_u32 v84, v24, v25, v26
    v_add_u32 v84, v84, v27
    s_waitcnt vmcnt(8)
    ds_write_b128 v45, v[28:31]
    v_add3_u32 v85, v28, v29, v30
    v_add_u32 v85, v85, v31
    s_waitcnt vmcnt(7)
    ds_write_b128 v46, v[32:35]
    v_add3_u32 v86, v32, v33, v34
    v_add_u32 v86, v86, v35
    s_waitcnt vmcnt(6)
    ds_write_b128 v47, v[36:39]
    v_add3_u32 v87, v36, v37, v38
    v_add_u32 v87, v87, v39
    v_cmp_ne_u32 s[12:13], v73, v5
    s_nop 0
    s_cmp_eq_u32 s12, 0
    s_cbranch_scc1 L_Agc
L_Agp:
    s_mov_b32 s13, 0
    s_quadmask_b32 s67, s12
    s_mov_b64 exec, s[12:13]
    buffer_load_dwordx2 v[72:73], v2, s[44:47], s11 offen sc1
    s_mov_b64 exec, -1

    s_bitcmp1_b32 s67, 0
    s_cbranch_scc0 L_Agl0
    buffer_load_dwordx4 v[8:11], v98, s[44:47], s9 offen offset:0 sc1
L_Agl0:
    s_bitcmp1_b32 s67, 1
    s_cbranch_scc0 L_Agl1
    buffer_load_dwordx4 v[12:15], v98, s[44:47], s9 offen offset:1024 sc1
L_Agl1:
    s_bitcmp1_b32 s67, 2
    s_cbranch_scc0 L_Agl2
    buffer_load_dwordx4 v[16:19], v98, s[44:47], s9 offen offset:2048 sc1
L_Agl2:
    s_bitcmp1_b32 s67, 3
    s_cbranch_scc0 L_Agl3
    buffer_load_dwordx4 v[20:23], v98, s[44:47], s9 offen offset:3072 sc1
L_Agl3:
    s_bitcmp1_b32 s67, 4
    s_cbranch_scc0 L_Agl4
    buffer_load_dwordx4 v[24:27], v98, s[44:47], s65 offen offset:0 sc1
L_Agl4:
    s_bitcmp1_b32 s67, 5
    s_cbranch_scc0 L_Agl5
    buffer_load_dwordx4 v[28:31], v98, s[44:47], s65 offen offset:1024 sc1
L_Agl5:
    s_bitcmp1_b32 s67, 6
    s_cbranch_scc0 L_Agl6
    buffer_load_dwordx4 v[32:35], v98, s[44:47], s65 offen offset:2048 sc1
L_Agl6:
    s_bitcmp1_b32 s67, 7
    s_cbranch_scc0 L_Agl7
    buffer_load_dwordx4 v[36:39], v98, s[44:47], s65 offen offset:3072 sc1
L_Agl7:
    s_add_u32 s8, s8, 1
    s_waitcnt vmcnt(0)
    v_cmp_ne_u32 s[12:13], v73, v5

    s_bitcmp1_b32 s67, 0
    s_cbranch_scc0 L_Agw0
    ds_write_b128 v40, v[8:11]
    v_add3_u32 v80, v8, v9, v10
    v_add_u32 v80, v80, v11
L_Agw0:
    s_bitcmp1_b32 s67, 1
    s_cbranch_scc0 L_Agw1
    ds_write_b128 v41, v[12:15]
    v_add3_u32 v81, v12, v13, v14
    v_add_u32 v81, v81, v15
L_Agw1:
    s_bitcmp1_b32 s67, 2
    s_cbranch_scc0 L_Agw2
    ds_write_b128 v42, v[16:19]
    v_add3_u32 v82, v16, v17, v18
    v_add_u32 v82, v82, v19
L_Agw2:
    s_bitcmp1_b32 s67, 3
    s_cbranch_scc0 L_Agw3
    ds_write_b128 v43, v[20:23]
    v_add3_u32 v83, v20, v21, v22
    v_add_u32 v83, v83, v23
L_Agw3:
    s_bitcmp1_b32 s67, 4
    s_cbranch_scc0 L_Agw4
    ds_write_b128 v44, v[24:27]
    v_add3_u32 v84, v24, v25, v26
    v_add_u32 v84, v84, v27
L_Agw4:
    s_bitcmp1_b32 s67, 5
    s_cbranch_scc0 L_Agw5
    ds_write_b128 v45, v[28:31]
    v_add3_u32 v85, v28, v29, v30
    v_add_u32 v85, v85, v31
L_Agw5:
    s_bitcmp1_b32 s67, 6
    s_cbranch_scc0 L_Agw6
    ds_write_b128 v46, v[32:35]
    v_add3_u32 v86, v32, v33, v34
    v_add_u32 v86, v86, v35
L_Agw6:
    s_bitcmp1_b32 s67, 7
    s_cbranch_scc0 L_Agw7
    ds_write_b128 v47, v[36:39]
    v_add3_u32 v87, v36, v37, v38
    v_add_u32 v87, v87, v39
L_Agw7:
    s_cmp_gt_u32 s8, 60000
    s_cbranch_scc1 L_Agp_x
    s_cmp_lg_u32 s12, 0
    s_cbranch_scc1 L_Agp
L_Agc:
    v_add3_u32 v4, v72, v80, v81
    v_add3_u32 v74, v82, v83, v84
    v_add3_u32 v4, v4, v85, v86
    v_add3_u32 v4, v4, v74, v87

    s_nop 1
    v_add_u32_dpp v4, v4, v4 quad_perm:[1,0,3,2] row_mask:0xf bank_mask:0xf
    s_nop 1
    v_add_u32_dpp v4, v4, v4 quad_perm:[2,3,0,1] row_mask:0xf bank_mask:0xf
    s_nop 1
    v_add_u32_dpp v4, v4, v4 row_half_mirror row_mask:0xf bank_mask:0xf
    s_nop 1
    v_add_u32_dpp v4, v4, v4 row_mirror row_mask:0xf bank_mask:0xf
    v_mov_b32 v74, v4
    s_nop 1
    v_permlane16_swap_b32 v4, v74
    v_add_u32 v4, v4, v74
    v_mov_b32 v74, v4
    s_nop 1
    v_permlane32_swap_b32 v4, v74
    v_add_u32 v4, v4, v74
    s_nop 0
    v_readfirstlane_b32 s10, v4
    s_mov_b32 s12, -1
    s_cmp_lg_u32 s10, s4
    s_cbranch_scc1 L_Agp
L_Agp_x:
    s_waitcnt lgkmcnt(0)

    s_barrier
    s_setprio 0
    s_add_u32 s10, s64, 0x3000
    buffer_load_dwordx4 v[152:155], v0, s[40:43], s10 offen nt
    s_add_u32 s10, s64, 0x3100
    buffer_load_dwordx4 v[156:159], v0, s[40:43], s10 offen nt
    s_add_u32 s10, s64, 0x200
    buffer_load_dwordx4 v[160:163], v3, s[40:43], s10 offen nt
    s_add_u32 s10, s64, 0x300
    buffer_load_dwordx4 v[164:167], v3, s[40:43], s10 offen nt
    v_and_b32 v102, 3, v1
    v_lshlrev_b32 v102, 2, v102
    v_add_u32 v102, 0x23010, v102
    s_lshl_b32 s10, s3, 2
    s_add_u32 s10, s10, 0x23020
    v_mov_b32 v103, s10
    s_barrier

    v_add_u32 v99, 1, v5
    ds_write_b32 v103, v99
    s_add_u32 s10, s64, 0x1200
    buffer_load_dwordx4 v[168:171], v3, s[40:43], s10 offen nt
    s_add_u32 s10, s64, 0x1300
    buffer_load_dwordx4 v[172:175], v3, s[40:43], s10 offen nt
    s_add_u32 s10, s64, 0x2200
    buffer_load_dwordx4 v[176:179], v0, s[40:43], s10 offen nt
    s_add_u32 s10, s64, 0x2300
    buffer_load_dwordx4 v[180:183], v0, s[40:43], s10 offen nt
    s_add_u32 s10, s64, 0x3200
    buffer_load_dwordx4 v[184:187], v0, s[40:43], s10 offen nt
    s_add_u32 s10, s64, 0x3300
    buffer_load_dwordx4 v[188:191], v0, s[40:43], s10 offen nt
    s_add_u32 s10, s64, 0x10000
    buffer_load_dwordx4 v[192:195], v3, s[40:43], s10 offen nt
    s_add_u32 s10, s64, 0x10100
    buffer_load_dwordx4 v[196:199], v3, s[40:43], s10 offen nt
    s_add_u32 s10, s64, 0x11000
    buffer_load_dwordx4 v[200:203], v3, s[40:43], s10 offen nt
    s_add_u32 s10, s64, 0x11100
    buffer_load_dwordx4 v[204:207], v3, s[40:43], s10 offen nt
    s_add_u32 s10, s64, 0x12000
    buffer_load_dwordx4 v[208:211], v0, s[40:43], s10 offen nt
    s_add_u32 s10, s64, 0x12100
    buffer_load_dwordx4 v[212:215], v0, s[40:43], s10 offen nt
    s_mov_b32 s11, 0
L_Ay0:
    ds_read_b32 v99, v102
    s_add_u32 s11, s11, 1
    s_waitcnt lgkmcnt(0)
    v_sub_u32 v99, v99, v5
    v_subrev_u32 v99, 0, v99
    v_cmp_lt_u32 vcc, 7, v99
    s_cmp_gt_u32 s11, 200000
    s_cbranch_scc1 L_Ay0x
    s_cbranch_vccz L_Ay0x
    s_sleep 1
    s_branch L_Ay0
L_Ay0x:

    s_waitcnt vmcnt(21)
    ds_write_b128 v100, v[128:131] offset:0
    s_waitcnt vmcnt(20)
    ds_write_b128 v100, v[132:135] offset:1024
    s_waitcnt vmcnt(19)
    ds_write_b128 v100, v[136:139] offset:4096
    s_waitcnt vmcnt(18)
    ds_write_b128 v100, v[140:143] offset:5120
    s_waitcnt vmcnt(17)
    ds_write_b128 v100, v[144:147] offset:8192
    s_waitcnt vmcnt(16)
    ds_write_b128 v100, v[148:151] offset:9216
    s_waitcnt vmcnt(15)
    ds_write_b128 v100, v[152:155] offset:12288
    v_add_u32 v99, 2, v5
    s_waitcnt vmcnt(14)
    ds_write_b128 v100, v[156:159] offset:13312
    ds_write_b32 v103, v99
    s_waitcnt vmcnt(13)
    ds_write_b128 v100, v[160:163] offset:2048
    s_add_u32 s10, s64, 0x13000
    buffer_load_dwordx4 v[216:219], v0, s[40:43], s10 offen nt
    s_add_u32 s10, s64, 0x13100
    buffer_load_dwordx4 v[220:223], v0, s[40:43], s10 offen nt
    s_waitcnt vmcnt(14)
    ds_write_b128 v100, v[164:167] offset:3072
    s_waitcnt vmcnt(13)
    ds_write_b128 v100, v[168:171] offset:6144
    s_waitcnt vmcnt(12)
    ds_write_b128 v100, v[172:175] offset:7168
    s_waitcnt vmcnt(11)
    ds_write_b128 v100, v[176:179] offset:10240
    s_waitcnt vmcnt(10)
    ds_write_b128 v100, v[180:183] offset:11264
    s_waitcnt vmcnt(9)
    ds_write_b128 v100, v[184:187] offset:14336
    v_add_u32 v99, 4, v5
    s_waitcnt vmcnt(8)
    ds_write_b128 v100, v[188:191] offset:15360
    ds_write_b32 v103, v99
    s_mov_b32 s11, 0
L_Ay1:
    ds_read_b32 v99, v102
    s_add_u32 s11, s11, 1
    s_waitcnt lgkmcnt(0)
    v_sub_u32 v99, v99, v5
    v_subrev_u32 v99, 1, v99
    v_cmp_lt_u32 vcc, 7, v99
    s_cmp_gt_u32 s11, 200000
    s_cbranch_scc1 L_Ay1x
    s_cbranch_vccz L_Ay1x
    s_sleep 1
    s_branch L_Ay1
L_Ay1x:

    s_lshl_b32 s9, s3, 14
    s_add_u32 m0, s9, 0x10800
    s_add_u32 s10, s64, 0x10200
    buffer_load_dwordx4 v3, s[40:43], s10 offen nt lds
    s_add_u32 m0, s9, 0x10c00
    s_add_u32 s10, s64, 0x10300
    buffer_load_dwordx4 v3, s[40:43], s10 offen nt lds
    s_add_u32 m0, s9, 0x11800
    s_add_u32 s10, s64, 0x11200
    buffer_load_dwordx4 v3, s[40:43], s10 offen nt lds
    s_add_u32 m0, s9, 0x11c00
    s_add_u32 s10, s64, 0x11300
    buffer_load_dwordx4 v3, s[40:43], s10 offen nt lds
    s_add_u32 m0, s9, 0x12800
    s_add_u32 s10, s64, 0x12200
    buffer_load_dwordx4 v0, s[40:43], s10 offen nt lds
    s_add_u32 m0, s9, 0x12c00
    s_add_u32 s10, s64, 0x12300
    buffer_load_dwordx4 v0, s[40:43], s10 offen nt lds
    s_add_u32 m0, s9, 0x13800
    s_add_u32 s10, s64, 0x13200
    buffer_load_dwordx4 v0, s[40:43], s10 offen nt lds
    s_add_u32 m0, s9, 0x13c00
    s_add_u32 s10, s64, 0x13300
    buffer_load_dwordx4 v0, s[40:43], s10 offen nt lds
    s_waitcnt vmcnt(15)
    ds_write_b128 v101, v[192:195] offset:0
    s_waitcnt vmcnt(14)
    ds_write_b128 v101, v[196:199] offset:1024
    s_waitcnt vmcnt(13)
    ds_write_b128 v101, v[200:203] offset:4096
    s_waitcnt vmcnt(12)
    ds_write_b128 v101, v[204:207] offset:5120
    s_waitcnt vmcnt(11)
    ds_write_b128 v101, v[208:211] offset:8192
    s_waitcnt vmcnt(10)
    ds_write_b128 v101, v[212:215] offset:9216
    s_waitcnt vmcnt(9)
    ds_write_b128 v101, v[216:219] offset:12288
    v_add_u32 v99, 6, v5
    s_waitcnt vmcnt(8)
    ds_write_b128 v101, v[220:223] offset:13312
    ds_write_b32 v103, v99
    s_waitcnt vmcnt(0)
    s_waitcnt lgkmcnt(0)
    s_barrier
    s_endpgm
L_Arf0:
    s_waitcnt lgkmcnt(0)
    s_barrier
    v_mbcnt_lo_u32_b32 v1, -1, 0
    v_mbcnt_hi_u32_b32 v1, -1, v1
    v_lshrrev_b32 v0, 4, v1
    v_and_b32 v1, 15, v1
    v_lshlrev_b32 v1, 4, v1
    v_mul_u32_u24 v0, 0x440, v0
    v_xor_b32 v1, v1, v0
    v_xor_b32 v0, 32, v1

    s_add_u32 m0, s9, 0x0
    s_add_u32 s10, s8, 0x20000
    buffer_load_dwordx4 v1, s[40:43], s10 offen nt lds
    s_add_u32 m0, s9, 0x1000
    s_add_u32 s10, s8, 0x21000
    buffer_load_dwordx4 v1, s[40:43], s10 offen nt lds
    s_add_u32 m0, s9, 0x2000
    s_add_u32 s10, s8, 0x22000
    buffer_load_dwordx4 v0, s[40:43], s10 offen nt lds
    s_add_u32 m0, s9, 0x3000
    s_add_u32 s10, s8, 0x23000
    buffer_load_dwordx4 v0, s[40:43], s10 offen nt lds
    s_add_u32 m0, s9, 0x400
    s_add_u32 s10, s8, 0x20100
    buffer_load_dwordx4 v1, s[40:43], s10 offen nt lds
    s_add_u32 m0, s9, 0x1400
    s_add_u32 s10, s8, 0x21100
    buffer_load_dwordx4 v1, s[40:43], s10 offen nt lds
    s_add_u32 m0, s9, 0x2400
    s_add_u32 s10, s8, 0x22100
    buffer_load_dwordx4 v0, s[40:43], s10 offen nt lds
    s_add_u32 m0, s9, 0x3400
    s_add_u32 s10, s8, 0x23100
    buffer_load_dwordx4 v0, s[40:43], s10 offen nt lds
    s_add_u32 m0, s9, 0x800
    s_add_u32 s10, s8, 0x20200
    buffer_load_dwordx4 v1, s[40:43], s10 offen nt lds
    s_add_u32 m0, s9, 0x1800
    s_add_u32 s10, s8, 0x21200
    buffer_load_dwordx4 v1, s[40:43], s10 offen nt lds
    s_add_u32 m0, s9, 0x2800
    s_add_u32 s10, s8, 0x22200
    buffer_load_dwordx4 v0, s[40:43], s10 offen nt lds
    s_add_u32 m0, s9, 0x3800
    s_add_u32 s10, s8, 0x23200
    buffer_load_dwordx4 v0, s[40:43], s10 offen nt lds
    s_add_u32 m0, s9, 0xc00
    s_add_u32 s10, s8, 0x20300
    buffer_load_dwordx4 v1, s[40:43], s10 offen nt lds
    s_add_u32 m0, s9, 0x1c00
    s_add_u32 s10, s8, 0x21300
    buffer_load_dwordx4 v1, s[40:43], s10 offen nt lds
    s_add_u32 m0, s9, 0x2c00
    s_add_u32 s10, s8, 0x22300
    buffer_load_dwordx4 v0, s[40:43], s10 offen nt lds
    s_add_u32 m0, s9, 0x3c00
    s_add_u32 s10, s8, 0x23300
    buffer_load_dwordx4 v0, s[40:43], s10 offen nt lds
    v_mbcnt_lo_u32_b32 v0, -1, 0
    v_and_b32 v0, 3, v0
    v_lshlrev_b32 v0, 2, v0
    v_add_u32 v0, 0x23000, v0
    s_waitcnt vmcnt(0)
    s_barrier
    s_branch L_Arb0

L_Arf1:
    s_waitcnt lgkmcnt(0)
    s_barrier
    v_mbcnt_lo_u32_b32 v1, -1, 0
    v_mbcnt_hi_u32_b32 v1, -1, v1
    v_lshrrev_b32 v0, 4, v1
    v_and_b32 v1, 15, v1
    v_lshlrev_b32 v1, 4, v1
    v_mul_u32_u24 v0, 0x440, v0
    v_xor_b32 v1, v1, v0
    v_xor_b32 v0, 32, v1

    s_add_u32 m0, s9, 0x10000
    s_add_u32 s10, s8, 0x30000
    buffer_load_dwordx4 v1, s[40:43], s10 offen nt lds
    s_add_u32 m0, s9, 0x11000
    s_add_u32 s10, s8, 0x31000
    buffer_load_dwordx4 v1, s[40:43], s10 offen nt lds
    s_add_u32 m0, s9, 0x12000
    s_add_u32 s10, s8, 0x32000
    buffer_load_dwordx4 v0, s[40:43], s10 offen nt lds
    s_add_u32 m0, s9, 0x13000
    s_add_u32 s10, s8, 0x33000
    buffer_load_dwordx4 v0, s[40:43], s10 offen nt lds
    s_add_u32 m0, s9, 0x10400
    s_add_u32 s10, s8, 0x30100
    buffer_load_dwordx4 v1, s[40:43], s10 offen nt lds
    s_add_u32 m0, s9, 0x11400
    s_add_u32 s10, s8, 0x31100
    buffer_load_dwordx4 v1, s[40:43], s10 offen nt lds
    s_add_u32 m0, s9, 0x12400
    s_add_u32 s10, s8, 0x32100
    buffer_load_dwordx4 v0, s[40:43], s10 offen nt lds
    s_add_u32 m0, s9, 0x13400
    s_add_u32 s10, s8, 0x33100
    buffer_load_dwordx4 v0, s[40:43], s10 offen nt lds
    s_add_u32 m0, s9, 0x10800
    s_add_u32 s10, s8, 0x30200
    buffer_load_dwordx4 v1, s[40:43], s10 offen nt lds
    s_add_u32 m0, s9, 0x11800
    s_add_u32 s10, s8, 0x31200
    buffer_load_dwordx4 v1, s[40:43], s10 offen nt lds
    s_add_u32 m0, s9, 0x12800
    s_add_u32 s10, s8, 0x32200
    buffer_load_dwordx4 v0, s[40:43], s10 offen nt lds
    s_add_u32 m0, s9, 0x13800
    s_add_u32 s10, s8, 0x33200
    buffer_load_dwordx4 v0, s[40:43], s10 offen nt lds
    s_add_u32 m0, s9, 0x10c00
    s_add_u32 s10, s8, 0x30300
    buffer_load_dwordx4 v1, s[40:43], s10 offen nt lds
    s_add_u32 m0, s9, 0x11c00
    s_add_u32 s10, s8, 0x31300
    buffer_load_dwordx4 v1, s[40:43], s10 offen nt lds
    s_add_u32 m0, s9, 0x12c00
    s_add_u32 s10, s8, 0x32300
    buffer_load_dwordx4 v0, s[40:43], s10 offen nt lds
    s_add_u32 m0, s9, 0x13c00
    s_add_u32 s10, s8, 0x33300
    buffer_load_dwordx4 v0, s[40:43], s10 offen nt lds
    v_mbcnt_lo_u32_b32 v0, -1, 0
    v_and_b32 v0, 3, v0
    v_lshlrev_b32 v0, 2, v0
    v_add_u32 v0, 0x23000, v0
    s_waitcnt vmcnt(0)
    s_barrier
    s_branch L_Arb1

L_Apc_1:
    s_mov_b32 s11, 0
L_Apc_1l:
    ds_read_b32 v1, v0 offset:0
    s_add_u32 s11, s11, 1
    s_waitcnt lgkmcnt(0)
    v_subrev_u32 v1, s63, v1
    v_cmp_lt_u32 vcc, 7, v1
    s_cmp_gt_u32 s11, 200000
    s_cbranch_scc1 L_Apc_1r
    s_cbranch_vccnz L_Apc_1l
L_Apc_1r:

    s_branch L_Apc_1b

L_Apc_2:
    s_mov_b32 s11, 0
L_Apc_2l:
    ds_read_b32 v1, v0 offset:0
    s_add_u32 s11, s11, 1
    s_waitcnt lgkmcnt(0)
    v_subrev_u32 v1, s63, v1
    v_cmp_lt_u32 vcc, 7, v1
    s_cmp_gt_u32 s11, 200000
    s_cbranch_scc1 L_Apc_2r
    s_cbranch_vccnz L_Apc_2l
L_Apc_2r:

    s_branch L_Apc_2b

L_Ahc_3:
    s_mov_b32 s11, 0
L_Ahc_3l:
    ds_read_b32 v1, v3 offset:32
    s_add_u32 s11, s11, 1
    s_waitcnt lgkmcnt(0)
    v_readfirstlane_b32 s62, v1
    s_nop 0
    s_sub_u32 s62, s62, s57
    s_cmp_gt_u32 s62, 15
    s_cselect_b32 s62, 0, s62
    s_cmp_gt_u32 s11, 200000
    s_cbranch_scc1 L_Ahc_3b
    s_cmp_lt_u32 s62, 2
    s_cbranch_scc1 L_Ahc_3l
    s_branch L_Ahc_3b

L_Ahc_4:
    s_mov_b32 s11, 0
L_Ahc_4l:
    ds_read_b32 v1, v3 offset:32
    s_add_u32 s11, s11, 1
    s_waitcnt lgkmcnt(0)
    v_readfirstlane_b32 s62, v1
    s_nop 0
    s_sub_u32 s62, s62, s57
    s_cmp_gt_u32 s62, 15
    s_cselect_b32 s62, 0, s62
    s_cmp_gt_u32 s11, 200000
    s_cbranch_scc1 L_Ahc_4b
    s_cmp_lt_u32 s62, 4
    s_cbranch_scc1 L_Ahc_4l
    s_branch L_Ahc_4b

L_Apc_5:
    s_mov_b32 s11, 0
L_Apc_5l:
    ds_read_b32 v1, v0 offset:32
    s_add_u32 s11, s11, 1
    s_waitcnt lgkmcnt(0)
    v_subrev_u32 v1, s63, v1
    v_cmp_lt_u32 vcc, 7, v1
    s_cmp_gt_u32 s11, 200000
    s_cbranch_scc1 L_Apc_5r
    s_cbranch_vccnz L_Apc_5l
L_Apc_5r:

    s_branch L_Apc_5b

L_Apc_6:
    s_mov_b32 s11, 0
L_Apc_6l:
    ds_read_b32 v1, v0 offset:0
    s_add_u32 s11, s11, 1
    s_waitcnt lgkmcnt(0)
    v_subrev_u32 v1, s63, v1
    v_cmp_lt_u32 vcc, 7, v1
    s_cmp_gt_u32 s11, 200000
    s_cbranch_scc1 L_Apc_6r
    s_cbranch_vccnz L_Apc_6l
L_Apc_6r:
    ds_read_b128 v[32:35], v5 offset:0
    ds_read_b128 v[36:39], v5 offset:1024
    ds_read_b128 v[40:43], v5 offset:2048
    ds_read_b128 v[44:47], v5 offset:3072
    s_waitcnt lgkmcnt(0)
    s_branch L_Apc_6b

L_Ahc_7:
    s_mov_b32 s11, 0
L_Ahc_7l:
    ds_read_b32 v1, v3 offset:32
    s_add_u32 s11, s11, 1
    s_waitcnt lgkmcnt(0)
    v_readfirstlane_b32 s62, v1
    s_nop 0
    s_sub_u32 s62, s62, s57
    s_cmp_gt_u32 s62, 15
    s_cselect_b32 s62, 0, s62
    s_cmp_gt_u32 s11, 200000
    s_cbranch_scc1 L_Ahc_7b
    s_cmp_lt_u32 s62, 6
    s_cbranch_scc1 L_Ahc_7l
    s_branch L_Ahc_7b

L_Apc_8:
    s_mov_b32 s11, 0
L_Apc_8l:
    ds_read_b32 v1, v0 offset:32
    s_add_u32 s11, s11, 1
    s_waitcnt lgkmcnt(0)
    v_subrev_u32 v1, s63, v1
    v_cmp_lt_u32 vcc, 7, v1
    s_cmp_gt_u32 s11, 200000
    s_cbranch_scc1 L_Apc_8r
    s_cbranch_vccnz L_Apc_8l
L_Apc_8r:

    s_branch L_Apc_8b

L_Aslow:
    v_lshlrev_b32 v30, 2, v27
    v_add_u32 v30, 0x23100, v30
    s_cmp_lg_u32 s15, 0
    s_cbranch_scc1 L_Aslow2
    ds_write2st64_b32 v26, v8, v9 offset0:8 offset1:12
    s_waitcnt lgkmcnt(0)
    s_barrier
    ds_read_b128 v[224:227], v28 offset:2048
    ds_read_b128 v[228:231], v28 offset:2064
    s_waitcnt lgkmcnt(0)
    v_max3_f32 v224, v224, v225, v226
    v_max3_f32 v227, v227, v228, v229
    v_max3_f32 v224, v224, v230, v231
    v_max_f32 v184, v224, v227
    s_nop 1
    v_max_f32_dpp v184, v184, v184 quad_perm:[2,3,0,1] row_mask:0xf bank_mask:0xf
    v_ceil_f32 v184, v184
    ds_write_b32 v30, v184
    v_and_b32 v31, 15, v24
    v_lshlrev_b32 v30, 2, v31
    v_add_u32 v30, 0x23100, v30
    v_lshrrev_b32 v232, 4, v24
    v_lshlrev_b32 v232, 4, v232
    v_lshl_add_u32 v31, v31, 10, v232
    s_mov_b32 s10, 0x4000
    s_waitcnt vmcnt(0) lgkmcnt(0)
    ds_read_b32 v10, v30
    ds_read_b32 v11, v30 offset:64

    buffer_load_dwordx4 v[128:131], v31, s[44:47], 0 offen offset:0 sc1
    buffer_load_dwordx4 v[132:135], v31, s[44:47], 0 offen offset:64 sc1
    buffer_load_dwordx4 v[136:139], v31, s[44:47], 0 offen offset:128 sc1
    buffer_load_dwordx4 v[140:143], v31, s[44:47], 0 offen offset:192 sc1
    buffer_load_dwordx4 v[144:147], v31, s[44:47], 0 offen offset:256 sc1
    buffer_load_dwordx4 v[148:151], v31, s[44:47], 0 offen offset:320 sc1
    buffer_load_dwordx4 v[152:155], v31, s[44:47], 0 offen offset:384 sc1
    buffer_load_dwordx4 v[156:159], v31, s[44:47], 0 offen offset:448 sc1
    buffer_load_dwordx4 v[160:163], v31, s[44:47], 0 offen offset:512 sc1
    buffer_load_dwordx4 v[164:167], v31, s[44:47], 0 offen offset:576 sc1
    buffer_load_dwordx4 v[168:171], v31, s[44:47], 0 offen offset:640 sc1
    buffer_load_dwordx4 v[172:175], v31, s[44:47], 0 offen offset:704 sc1
    buffer_load_dwordx4 v[176:179], v31, s[44:47], 0 offen offset:768 sc1
    buffer_load_dwordx4 v[180:183], v31, s[44:47], 0 offen offset:832 sc1
    buffer_load_dwordx4 v[184:187], v31, s[44:47], 0 offen offset:896 sc1
    buffer_load_dwordx4 v[188:191], v31, s[44:47], 0 offen offset:960 sc1
    buffer_load_dwordx4 v[192:195], v31, s[44:47], s10 offen offset:0 sc1
    buffer_load_dwordx4 v[196:199], v31, s[44:47], s10 offen offset:64 sc1
    buffer_load_dwordx4 v[200:203], v31, s[44:47], s10 offen offset:128 sc1
    buffer_load_dwordx4 v[204:207], v31, s[44:47], s10 offen offset:192 sc1
    buffer_load_dwordx4 v[208:211], v31, s[44:47], s10 offen offset:256 sc1
    buffer_load_dwordx4 v[212:215], v31, s[44:47], s10 offen offset:320 sc1
    buffer_load_dwordx4 v[216:219], v31, s[44:47], s10 offen offset:384 sc1
    buffer_load_dwordx4 v[220:223], v31, s[44:47], s10 offen offset:448 sc1
    buffer_load_dwordx4 v[224:227], v31, s[44:47], s10 offen offset:512 sc1
    buffer_load_dwordx4 v[228:231], v31, s[44:47], s10 offen offset:576 sc1
    buffer_load_dwordx4 v[232:235], v31, s[44:47], s10 offen offset:640 sc1
    buffer_load_dwordx4 v[236:239], v31, s[44:47], s10 offen offset:704 sc1
    buffer_load_dwordx4 v[240:243], v31, s[44:47], s10 offen offset:768 sc1
    buffer_load_dwordx4 v[244:247], v31, s[44:47], s10 offen offset:832 sc1
    buffer_load_dwordx4 v[248:251], v31, s[44:47], s10 offen offset:896 sc1
    buffer_load_dwordx4 v[252:255], v31, s[44:47], s10 offen offset:960 sc1
    s_mov_b32 s15, 1
    s_waitcnt vmcnt(0) lgkmcnt(0)
    v_sub_f32 v10, 0, v10
    v_sub_f32 v11, 0, v11

    v_mbcnt_lo_u32_b32 v3, -1, 0
    v_mbcnt_hi_u32_b32 v3, -1, v3
    v_lshrrev_b32 v0, 4, v3
    v_and_b32 v3, 15, v3
    v_lshlrev_b32 v3, 4, v3
    v_mul_u32_u24 v0, 0x440, v0
    v_xor_b32 v3, v3, v0
    v_xor_b32 v0, 32, v3

    s_barrier
    s_branch L_Apass
L_Aslow2:
    ds_read_b32 v184, v30
    s_waitcnt lgkmcnt(0)
    s_branch L_Aok

L_Wgen:
    v_mov_b32 v12, v52
    s_nop 1
    v_max_f32_dpp v12, v12, v12 quad_perm:[1,0,3,2] row_mask:0xf bank_mask:0xf
    s_nop 1
    v_max_f32_dpp v12, v12, v12 quad_perm:[2,3,0,1] row_mask:0xf bank_mask:0xf
    s_nop 1
    v_max_f32_dpp v12, v12, v12 row_half_mirror row_mask:0xf bank_mask:0xf
    s_nop 1
    v_max_f32_dpp v12, v12, v12 row_mirror row_mask:0xf bank_mask:0xf
    v_sub_f32 v54, v52, v12
    v_exp_f32 v54, v54
    v_mov_b32 v52, v12
    v_and_b32 v54, 0xffff0000, v54
    v_mul_f32 v53, v53, v54
    v_lshrrev_b32 v55, 16, v54
    v_or_b32 v54, v54, v55
    v_lshlrev_b32 v13, 2, v6

    ds_bpermute_b32 v12, v13, v54 offset:0
    s_waitcnt lgkmcnt(0)
    v_and_b32 v136, v12, v56
    v_and_b32 v137, v12, v57
    v_and_b32 v138, v12, v58
    v_and_b32 v139, v12, v59
    ds_bpermute_b32 v12, v13, v54 offset:16
    s_waitcnt lgkmcnt(0)
    v_and_b32 v140, v12, v56
    v_and_b32 v141, v12, v57
    v_and_b32 v142, v12, v58
    v_and_b32 v143, v12, v59
    ds_bpermute_b32 v12, v13, v54 offset:32
    s_waitcnt lgkmcnt(0)
    v_and_b32 v144, v12, v56
    v_and_b32 v145, v12, v57
    v_and_b32 v146, v12, v58
    v_and_b32 v147, v12, v59
    ds_bpermute_b32 v12, v13, v54 offset:48
    s_waitcnt lgkmcnt(0)
    v_and_b32 v148, v12, v56
    v_and_b32 v149, v12, v57
    v_and_b32 v150, v12, v58
    v_and_b32 v151, v12, v59
    s_nop 1
    s_branch L_Wj
L_Wretry:
    s_cmp_gt_u32 s60, 60000
    s_cbranch_scc1 L_Wg_x
    s_mov_b64 s[62:63], -1

    v_and_b32 v136, 0x3f803f80, v56
    v_and_b32 v140, 0x3f803f80, v56
    v_and_b32 v144, 0x3f803f80, v56
    v_and_b32 v148, 0x3f803f80, v56
    v_and_b32 v137, 0x3f803f80, v57
    v_and_b32 v141, 0x3f803f80, v57
    v_and_b32 v145, 0x3f803f80, v57
    v_and_b32 v149, 0x3f803f80, v57
    v_and_b32 v138, 0x3f803f80, v58
    v_and_b32 v142, 0x3f803f80, v58
    v_and_b32 v146, 0x3f803f80, v58
    v_and_b32 v150, 0x3f803f80, v58
    v_and_b32 v139, 0x3f803f80, v59
    v_and_b32 v143, 0x3f803f80, v59
    v_and_b32 v147, 0x3f803f80, v59
    v_and_b32 v151, 0x3f803f80, v59
    s_branch L_Wg1
L_Wgen2:
    v_mov_b32 v12, v52
    s_nop 1
    v_max_f32_dpp v12, v12, v12 quad_perm:[1,0,3,2] row_mask:0xf bank_mask:0xf
    s_nop 1
    v_max_f32_dpp v12, v12, v12 quad_perm:[2,3,0,1] row_mask:0xf bank_mask:0xf
    s_nop 1
    v_max_f32_dpp v12, v12, v12 row_half_mirror row_mask:0xf bank_mask:0xf
    v_sub_f32 v54, v52, v12
    v_exp_f32 v54, v54
    v_and_b32 v13, 1, v6
    v_lshlrev_b32 v13, 4, v13
    v_mul_f32 v53, v53, v54

    ds_bpermute_b32 v12, v13, v54 offset:0
    s_waitcnt lgkmcnt(0)
    v_mul_f32 v32, v32, v12
    ds_bpermute_b32 v12, v13, v54 offset:4
    s_waitcnt lgkmcnt(0)
    v_mul_f32 v33, v33, v12
    ds_bpermute_b32 v12, v13, v54 offset:8
    s_waitcnt lgkmcnt(0)
    v_mul_f32 v34, v34, v12
    ds_bpermute_b32 v12, v13, v54 offset:12
    s_waitcnt lgkmcnt(0)
    v_mul_f32 v35, v35, v12
    s_nop 1
    s_branch L_Wj2
L_end:
    s_endpgm
.section .rodata,"a"
.p2align 6
.amdhsa_kernel recurrent_scan__compressed_kv_cla__dense_activation_silu__decode_kernel
  .amdhsa_next_free_vgpr 256
  .amdhsa_next_free_sgpr 96
  .amdhsa_accum_offset 256
  .amdhsa_group_segment_fixed_size 0
  .amdhsa_kernarg_size 96
  .amdhsa_user_sgpr_count 2
  .amdhsa_user_sgpr_kernarg_segment_ptr 1
  .amdhsa_system_sgpr_workgroup_id_x 1
  .amdhsa_float_denorm_mode_32 3
.end_amdhsa_kernel
```
